```python
import torch

def _softmax(x, axis=-1):
    return torch.softmax(x, dim=axis)
def _gelu(x):
    return torch.nn.functional.gelu(x, approximate="tanh")
def _silu(x):
    return torch.nn.functional.silu(x)
def _sigmoid(x):
    return torch.sigmoid(x)
def _layernorm(x, axis=-1, eps=1e-5):
    m = x.mean(dim=axis, keepdim=True)
    v = x.var(dim=axis, keepdim=True, unbiased=False)
    return (x - m) / torch.sqrt(v + eps)
def _scatter_add(tgt, idx, src, axis=0):
    return tgt.clone().index_add_(axis, idx, src)
def _segment_sum(src, seg, n):
    out = torch.zeros((n,) + src.shape[1:], dtype=src.dtype)
    return out.index_add_(0, seg, src)
def _pad(x, pw):
    flat = tuple(v for pair in reversed(pw) for v in pair)
    return torch.nn.functional.pad(x, flat)

kernel_name = 'concat_heads__grouped_kv_mqa__ssm_conv_h3__prompt'

def setup_inputs():

    _w = (lambda a: (lambda t: t.to(torch.bfloat16) if t.is_floating_point() else t)(torch.as_tensor(a)))
    def _A_setup():
        B, S, D, H = 1, 2048, 512, 32
        Dh = D // H
        return {
            "x": _w((lambda *s: torch.randn(*s, dtype=torch.bfloat16) * 0.05)(B, S, D)),
            "wq": _w((lambda *s: torch.randn(*s, dtype=torch.bfloat16) * 0.8)(D, H * Dh)),
            "wk": _w((lambda *s: torch.randn(*s, dtype=torch.bfloat16) * 0.8)(D, Dh)),
            "wv": _w((lambda *s: torch.randn(*s, dtype=torch.bfloat16) * 0.05)(D, Dh)),
            "wo": _w((lambda *s: torch.randn(*s, dtype=torch.bfloat16) * 0.05)(H * Dh, D)),
        }
    _A_in = _A_setup()

    def _B_setup():
        B, S, D = 1, 2048, 512
        ks = 4
        return {
            "q": _w((lambda *s: torch.randn(*s, dtype=torch.bfloat16) * 0.05)(B, S, D)),
            "k": _w((lambda *s: torch.randn(*s, dtype=torch.bfloat16) * 0.2)(B, S, D)),
            "v": _w((lambda *s: torch.randn(*s, dtype=torch.bfloat16) * 0.2)(B, S, D)),
            "shift_k": _w((lambda *s: torch.randn(*s, dtype=torch.bfloat16) * 0.2)(D, ks) * 0.5),
            "ssm_k": _w((lambda *s: torch.randn(*s, dtype=torch.bfloat16) * 0.4)(D, S) * (1.0 / S ** 0.5)),
            "ssm_D": _w((lambda *s: torch.randn(*s, dtype=torch.bfloat16) * 0.2)(D)),
        }
    _B_in = _B_setup()

    return {
        "A_x": _A_in["x"],
        "A_wq": _A_in["wq"],
        "A_wk": _A_in["wk"],
        "A_wv": _A_in["wv"],
        "A_wo": _A_in["wo"],
        "B_q": _B_in["q"],
        "B_k": _B_in["k"],
        "B_v": _B_in["v"],
        "B_shift_k": _B_in["shift_k"],
        "B_ssm_k": _B_in["ssm_k"],
        "B_ssm_D": _B_in["ssm_D"],
    }

def reference(A_x, A_wq, A_wk, A_wv, A_wo, B_q, B_k, B_v, B_shift_k, B_ssm_k, B_ssm_D):
    def _A_ref(x, wq, wk, wv, wo):
        B, S, D = x.shape
        H = 32
        Dh = D // H
        q = (lambda x, *d: x.permute(*d))((x @ wq).reshape(B, S, H, Dh), 0, 2, 1, 3)
        k = x @ wk
        v = x @ wv
        scores = torch.einsum("bhqd,bkd->bhqk", q, k) * (Dh ** -0.5)
        p = _softmax(scores, axis=-1)
        o = torch.einsum("bhqk,bkd->bhqd", p, v)
        return (lambda x, *d: x.permute(*d))(o, 0, 2, 1, 3).reshape(B, S, H * Dh) @ wo

    def _B_ref(q, k, v, shift_k, ssm_k, ssm_D):
        B, S, D = q.shape
        ks = shift_k.shape[-1]
        k_pad = _pad(k, ((0, 0), (ks - 1, 0), (0, 0)))
        k_shift = torch.zeros_like(k)
        for t in range(ks):
            k_shift = k_shift + k_pad[:, t:t + S, :] * shift_k[:, ks - 1 - t][None, None, :]
        kv = k_shift * v
        L = 2 * S
        kv_pad = _pad(kv, ((0, 0), (0, S), (0, 0)))
        kf_pad = _pad(ssm_k, ((0, 0), (0, S)))
        kv_f = (lambda x, axes=(-2,-1): torch.fft.rfft2(x.float(), dim=axes))(kv_pad[:, None, :, :], axes=(1, 2))
        kf_f = (lambda x, axes=(-2,-1): torch.fft.rfft2(x.float(), dim=axes))(kf_pad[:, None, :], axes=(1, 2))
        kf_f = (lambda x, *d: x.permute(*d))(kf_f, 1, 2, 0)
        y_f = kv_f * kf_f[None, :, :, :]
        y = (lambda x, s, axes=(-2,-1): torch.fft.irfft2(x, s=s, dim=axes).to(torch.bfloat16))(y_f, (1, L), axes=(1, 2))[:, 0, :S, :]
        y = y + kv * ssm_D[None, None, :]
        return q * y

    a = _A_ref(A_x, A_wq, A_wk, A_wv, A_wo)
    b = _B_ref(B_q, B_k, B_v, B_shift_k, B_ssm_k, B_ssm_D)
    return torch.concatenate([a, b], axis=-1)
```

```asm
; @launch grid=(256,1,1) block=(768,1,1) lds=163840
.amdgcn_target "amdgcn-amd-amdhsa--gfx950"
.text
.globl concat_heads__grouped_kv_mqa__ssm_conv_h3__prompt_kernel
.p2align 12
.type concat_heads__grouped_kv_mqa__ssm_conv_h3__prompt_kernel,@function
concat_heads__grouped_kv_mqa__ssm_conv_h3__prompt_kernel:
    s_cmp_ge_u32 s2, 256
    s_cbranch_scc1 L_end
    s_load_dwordx16 s[8:23], s[0:1], 0
    s_load_dwordx2 s[48:49], s[0:1], 104
    s_load_dwordx8 s[24:31], s[0:1], 64
    v_lshrrev_b32 v1, 6, v0
    v_and_b32 v0, 63, v0
    s_and_b32 s4, s2, 7
    v_readfirstlane_b32 s3, v1
    s_lshr_b32 s75, s2, 6
    s_lshl_b32 s5, s75, 3
    s_or_b32 s4, s4, s5
    s_bfe_u32 s5, s2, 0x30003
    s_lshl_b32 s2, s5, 5
    s_or_b32 s2, s2, s4
    v_lshlrev_b32 v6, 4, v0
    v_mov_b32 v7, 1
    v_mov_b32 v8, 0x30000
    v_mov_b32 v9, 0x27c00
    v_cmp_eq_u32 vcc, 0, v0
    s_movk_i32 s53, 20000
    s_and_b32 s54, s3, 3
    v_cndmask_b32 v3, v8, v9, vcc
    v_lshrrev_b32 v12, 4, v0
    v_and_b32 v13, 15, v0
    v_xor_b32 v13, v13, v12
    s_mov_b32 s38, 0x200000
    s_mov_b32 s39, 0x00020000
    s_mov_b32 s43, s39
    s_mov_b32 s50, 0xd00000
    s_mov_b32 s51, s39
    s_cmp_ge_u32 s3, 8
    s_cbranch_scc1 L_aux
    s_lshl_b32 s46, s75, 3
    s_add_u32 s46, s46, s3
    s_lshl_b32 s46, s46, 5
    s_add_u32 s46, s46, s5
    s_lshl_b32 s46, s46, 7
    s_cmp_ge_u32 s3, 4
    s_cbranch_scc1 L_p
    v_cmp_eq_u32 vcc, 7, v0
    v_lshl_add_u32 v9, v0, 2, v9
    s_cmp_eq_u32 s3, 2
    v_cndmask_b32 v8, 0, 64, vcc
    ds_write_b32 v9, v8
    s_cbranch_scc1 L_hop1
    s_cmp_eq_u32 s3, 3
    s_cbranch_scc1 L_hop2
    s_branch L_g
L_end:
    s_endpgm
L_aux:
    s_setprio 3
    v_lshlrev_b32 v13, 4, v13
    v_lshl_add_u32 v8, v12, 10, v13
    v_xor_b32 v9, 64, v8
    v_xor_b32 v10, 0x80, v8
    v_xor_b32 v11, 0xc0, v8
    v_add_u32 v9, 3072, v9
    v_add_u32 v10, 6144, v10
    v_add_u32 v11, 9216, v11
    s_lshr_b32 s55, s5, 1
    s_mov_b32 s74, s54
    s_movk_i32 s42, 16384
    s_lshl_b32 s57, s4, 2
    s_add_u32 s57, s57, s55
    s_lshl_b32 s57, s57, 6
    s_add_u32 s57, s57, s54
    s_lshl_b32 s57, s57, 8
    s_lshl_b32 s58, s74, 2
    s_add_u32 s58, s58, s55
    s_add_u32 s58, s58, 4
    s_lshl_b32 s58, s58, 12
    s_mov_b32 m0, s58
    s_lshl_b32 s59, s54, 12
    s_and_b32 s56, s5, 1
    s_waitcnt lgkmcnt(0)
    s_mov_b64 s[36:37], s[8:9]
    s_cselect_b64 s[40:41], s[14:15], s[12:13]
    buffer_load_dwordx4 v8, s[36:39], s57 offen lds
    buffer_load_dwordx4 v9, s[36:39], s57 offen offset:1024 lds
    buffer_load_dwordx4 v10, s[36:39], s57 offen offset:2048 lds
    buffer_load_dwordx4 v11, s[36:39], s57 offen offset:3072 lds
    s_mov_b32 m0, s59
    s_nop 0
    buffer_load_dwordx4 v6, s[40:43], s59 offen lds
    buffer_load_dwordx4 v6, s[40:43], s59 offen offset:1024 lds
    buffer_load_dwordx4 v6, s[40:43], s59 offen offset:2048 lds
    buffer_load_dwordx4 v6, s[40:43], s59 offen offset:3072 lds
    s_load_dword s52, s[48:49], 0x40000
    s_and_b32 s6, s4, 7
    s_lshl2_add_u32 s6, s6, s75
    s_lshl3_add_u32 s6, s6, s5
    s_lshl2_add_u32 s6, s6, s54
    s_lshl_b32 s6, s6, 8
    s_load_dword s44, s[48:49], s6 offset:0xc0000
    s_load_dword s44, s[48:49], s6 offset:0xc0040
    s_load_dword s44, s[48:49], s6 offset:0xc0080
    s_load_dword s44, s[48:49], s6 offset:0xc00c0
    s_barrier
    s_branch L_aux2
L_p:
    s_lshl_b32 s6, s54, 2
    v_xor_b32 v13, s6, v13
    v_lshlrev_b32 v13, 4, v13
    v_lshl_add_u32 v12, v12, 10, v13
    v_lshrrev_b32 v13, 3, v0
    v_and_b32 v14, 7, v0
    v_lshrrev_b32 v15, 2, v0
    v_and_b32 v15, 4, v15
    v_xor_b32 v14, v14, v15
    v_lshlrev_b32 v14, 4, v14
    v_lshl_add_u32 v13, v13, 10, v14
    v_add_u32 v15, 7168, v13
    v_add_u32 v16, 14336, v13
    v_add_u32 v17, 21504, v13
    v_mov_b32 v18, v3
    s_lshr_b32 s57, s5, 1
    s_lshl_b32 s58, s4, 4
    s_add_u32 s58, s58, s54
    s_lshl_b32 s58, s58, 12
    s_lshl_b32 s59, s54, 10
    s_bitset1_b32 s59, 14
    s_lshl_b32 s60, s54, 15
    s_lshl_b32 s7, s5, 7
    s_add_u32 s60, s60, s7
    s_lshl_b32 s61, s54, 12
    s_mov_b32 s42, 0x80000
    s_lshl_b32 s62, s75, 8
    s_mov_b32 s72, 3
    s_add_u32 s6, s57, 1
    s_and_b32 s6, s6, 3
    s_lshl_b32 s7, s6, 14
    s_add_u32 s66, s58, s7
    s_lshl_b32 s7, s6, 12
    s_add_u32 s69, s59, s7
    s_add_u32 s6, s57, 2
    s_and_b32 s6, s6, 3
    s_lshl_b32 s7, s6, 14
    s_add_u32 s67, s58, s7
    s_lshl_b32 s7, s6, 12
    s_add_u32 s70, s59, s7
    s_add_u32 s6, s57, 3
    s_and_b32 s6, s6, 3
    s_lshl_b32 s7, s6, 14
    s_add_u32 s68, s58, s7
    s_lshl_b32 s7, s6, 12
    s_add_u32 s71, s59, s7
    s_waitcnt lgkmcnt(0)
    s_load_dword s52, s[48:49], 0x40000
    s_add_u32 s46, s46, s10
    s_addc_u32 s47, s11, 0
    s_load_dwordx2 s[44:45], s[46:47], 0x3c
    s_load_dwordx2 s[44:45], s[46:47], 0x43c
    s_load_dwordx2 s[44:45], s[46:47], 0x83c
    s_load_dwordx2 s[44:45], s[46:47], 0xc3c
    s_mov_b64 s[36:37], s[8:9]
    s_mov_b64 s[40:41], s[10:11]
    s_barrier
    s_load_dwordx2 s[44:45], s[46:47], 0x2003c
    s_load_dwordx2 s[44:45], s[46:47], 0x2043c
    s_load_dwordx2 s[44:45], s[46:47], 0x2083c
    s_and_b32 s73, s4, 7
    s_lshl_b32 s73, s73, 2
    s_add_u32 s73, s73, s54
    s_lshl_b32 s73, s73, 13
    s_add_u32 s73, s73, 0xc0000
    s_add_u32 s74, s73, 0x1000
    s_lshl_b32 s58, s54, 12
    v_lshrrev_b32 v8, 4, v0
    v_and_b32 v9, 15, v0
    v_lshlrev_b32 v9, 4, v9
    v_add_u32 v9, s58, v9
    v_and_b32 v10, 1, v8
    v_lshrrev_b32 v11, 1, v8
    v_lshl_add_u32 v8, v10, 9, v9
    v_lshl_add_u32 v8, v11, 3, v8
    v_lshl_add_u32 v9, v11, 9, v9
    v_lshl_add_u32 v9, v10, 3, v9
    s_mov_b32 s64, 0xffff
    s_mov_b32 s65, s64
    v_mov_b32 v2, 0xdddddddd
    v_mov_b32 v4, v3
    v_add_u32 v1, 0x800, v6
    v_and_b32 v40, 27, v0
    v_mov_b32 v41, 0x3f803f80
    v_cmp_eq_u32 vcc, 16, v40
    v_lshrrev_b32 v161, 5, v0
    v_lshlrev_b32 v161, 9, v161
    v_cndmask_b32 v24, 0, v41, vcc
    v_cndmask_b32 v25, 0, v41, vcc
    s_xor_b32 s7, s54, 2
    s_lshr_b32 s55, s7, 1
    s_lshl_b32 s6, s7, 12
    s_add_u32 s6, s6, 115712
    v_add_u32 v162, s6, v6
    s_lshl_b32 s6, s7, 2
    v_add_u32 v163, s6, v3
    s_and_b32 s6, s7, 1
    s_lshl_b32 s56, s4, 1
    s_add_u32 s56, s56, s6
    s_lshl_b32 s56, s56, 3
    s_add_u32 s56, s56, s5
    s_lshl_b32 s56, s56, 1
    s_add_u32 s56, s56, s55
    s_lshl_b32 s56, s56, 11
    s_add_u32 s56, s56, 0x500000
    v_mov_b64 v[26:27], v[24:25]
    v_mov_b64 v[28:29], v[24:25]
    v_mov_b64 v[30:31], v[24:25]
    v_mov_b64 v[32:33], v[24:25]
    v_mov_b64 v[34:35], v[24:25]
    v_mov_b64 v[36:37], v[24:25]
    v_mov_b64 v[38:39], v[24:25]
    v_mov_b64 v[96:97], 0
    v_mov_b64 v[98:99], 0
    v_mov_b64 v[100:101], 0
    v_mov_b64 v[102:103], 0
    v_mov_b64 v[104:105], 0
    v_mov_b64 v[106:107], 0
    v_mov_b64 v[108:109], 0
    v_mov_b64 v[110:111], 0
    v_mov_b64 v[112:113], 0
    v_mov_b64 v[114:115], 0
    v_mov_b64 v[116:117], 0
    v_mov_b64 v[118:119], 0
    v_mov_b64 v[120:121], 0
    v_mov_b64 v[122:123], 0
    v_mov_b64 v[124:125], 0
    v_mov_b64 v[126:127], 0
    v_mov_b64 v[72:73], 0
    v_mov_b64 v[74:75], 0
    v_mov_b64 v[76:77], 0
    v_mov_b64 v[78:79], 0
    v_lshl_add_u32 v40, s3, 11, v6
    v_xor_b32 v41, 0x3000, v40
    v_lshrrev_b32 v42, 3, v40
    v_lshl_add_u32 v42, v0, 1, v42
    v_xor_b32 v43, 0x600, v42
    v_add_u32 v42, 160256, v42
    v_add_u32 v43, 160256, v43
    v_lshl_add_u32 v44, s3, 2, v3
    v_xor_b32 v45, 24, v44
    v_lshl_add_u32 v47, s55, 3, v3
    s_load_dwordx2 s[44:45], s[46:47], 0x20c3c
L_st:
    s_lshl_b32 s63, s62, 6
    v_or_b32 v14, s62, v12
    s_add_u32 m0, s69, s63
    s_add_u32 s62, s62, 0x100
    buffer_load_dwordx4 v14, s[36:39], s66 offen lds
    s_add_u32 m0, s70, s63
    s_and_b32 s62, s62, 0x300
    buffer_load_dwordx4 v14, s[36:39], s67 offen lds
    s_add_u32 m0, s71, s63
    s_sub_u32 s72, s72, 1
    buffer_load_dwordx4 v14, s[36:39], s68 offen lds
    s_cbranch_scc0 L_st
    s_add_u32 m0, s61, 81920
    s_mov_b32 s7, s60
    buffer_load_dwordx4 v13, s[40:43], s7 offen lds
    buffer_load_dwordx4 v15, s[40:43], s7 offen offset:1024 lds
    buffer_load_dwordx4 v16, s[40:43], s7 offen offset:2048 lds
    buffer_load_dwordx4 v17, s[40:43], s7 offen offset:3072 lds
    s_add_u32 m0, s61, 98304
    s_add_u32 s7, s60, 131072
    buffer_load_dwordx4 v13, s[40:43], s7 offen lds
    buffer_load_dwordx4 v15, s[40:43], s7 offen offset:1024 lds
    buffer_load_dwordx4 v16, s[40:43], s7 offen offset:2048 lds
    buffer_load_dwordx4 v17, s[40:43], s7 offen offset:3072 lds
    s_waitcnt vmcnt(8)
    ds_add_u32 v3, v7 offset:136
    s_add_u32 m0, s61, 130048
    s_add_u32 s7, s60, 262144
    buffer_load_dwordx4 v13, s[40:43], s7 offen lds
    buffer_load_dwordx4 v15, s[40:43], s7 offen offset:1024 lds
    buffer_load_dwordx4 v16, s[40:43], s7 offen offset:2048 lds
    buffer_load_dwordx4 v17, s[40:43], s7 offen offset:3072 lds
    s_waitcnt vmcnt(8)
    ds_add_u32 v3, v7 offset:120
    s_add_u32 m0, s61, 146432
    s_add_u32 s7, s60, 393216
    buffer_load_dwordx4 v13, s[40:43], s7 offen lds
    buffer_load_dwordx4 v15, s[40:43], s7 offen offset:1024 lds
    buffer_load_dwordx4 v16, s[40:43], s7 offen offset:2048 lds
    buffer_load_dwordx4 v17, s[40:43], s7 offen offset:3072 lds
    ds_read_b32 v5, v3 offset:44
    s_waitcnt vmcnt(8)
    ds_add_u32 v3, v7 offset:124
    s_waitcnt vmcnt(4)
    ds_add_u32 v3, v7 offset:128
    s_waitcnt lgkmcnt(0)
    v_readfirstlane_b32 s6, v5
    s_add_u32 s52, s52, 1
    s_cmp_lt_u32 s6, 99
    s_cbranch_scc1 L_tlate
    buffer_load_dwordx4 v[128:131], v6, s[48:51], s73 offen sc1
    buffer_load_dwordx4 v[132:135], v6, s[48:51], s73 offen offset:1024 sc1
    buffer_load_dwordx4 v[136:139], v6, s[48:51], s73 offen offset:2048 sc1
    buffer_load_dwordx4 v[140:143], v6, s[48:51], s73 offen offset:3072 sc1
    s_waitcnt vmcnt(4)
    ds_add_u32 v3, v7 offset:132
    buffer_load_dwordx4 v[80:83], v6, s[48:51], s74 offen sc1
    buffer_load_dwordx4 v[84:87], v6, s[48:51], s74 offen offset:1024 sc1
    buffer_load_dwordx4 v[88:91], v6, s[48:51], s74 offen offset:2048 sc1
    buffer_load_dwordx4 v[92:95], v6, s[48:51], s74 offen offset:3072 sc1
    ds_add_u32 v3, v7 offset:156
L_tchk:
    s_mov_b64 s[70:71], 0
    s_waitcnt vmcnt(7)
    ds_write_b64 v8, v[128:129] offset:0
    v_cmp_ne_u32 vcc, s52, v130
    s_or_b64 s[70:71], s[70:71], vcc
    s_waitcnt vmcnt(6)
    ds_write_b64 v9, v[132:133] offset:1024
    v_cmp_ne_u32 vcc, s52, v134
    s_or_b64 s[70:71], s[70:71], vcc
    s_waitcnt vmcnt(5)
    ds_write_b64 v8, v[136:137] offset:256
    v_cmp_ne_u32 vcc, s52, v138
    s_or_b64 s[70:71], s[70:71], vcc
    s_waitcnt vmcnt(4)
    ds_write_b64 v9, v[140:141] offset:1280
    v_cmp_ne_u32 vcc, s52, v142
    s_or_b64 s[70:71], s[70:71], vcc
    s_waitcnt vmcnt(3)
    ds_write_b64 v8, v[80:81] offset:2048
    v_cmp_ne_u32 vcc, s52, v82
    s_or_b64 s[70:71], s[70:71], vcc
    s_waitcnt vmcnt(2)
    ds_write_b64 v9, v[84:85] offset:3072
    v_cmp_ne_u32 vcc, s52, v86
    s_or_b64 s[70:71], s[70:71], vcc
    s_waitcnt vmcnt(1)
    ds_write_b64 v8, v[88:89] offset:2304
    v_cmp_ne_u32 vcc, s52, v90
    s_or_b64 s[70:71], s[70:71], vcc
    s_waitcnt vmcnt(0)
    ds_write_b64 v9, v[92:93] offset:3328
    v_cmp_ne_u32 vcc, s52, v94
    s_or_b64 s[70:71], s[70:71], vcc
    s_cbranch_scc1 L_tretry
L_tok:
    ds_add_u32 v3, v7 offset:56
L_lw_1:
    ds_read_b32 v5, v3 offset:56
    s_waitcnt lgkmcnt(0)
    v_readfirstlane_b32 s6, v5
    s_cmp_lt_u32 s6, 4
    s_cbranch_scc1 L_lw_1
    ds_read_b128 v[164:167], v161 offset:0
    ds_read_b128 v[16:19], v1 offset:0
    s_mov_b64 exec, s[64:65]
    ds_read_b128 v[24:27], v1 offset:1024
    ds_read_b128 v[28:31], v1 offset:1280
    s_mov_b64 exec, -1
    ds_read_b128 v[20:23], v1 offset:4096
    s_mov_b32 s66, 0
    s_mov_b32 s69, 0x5d800000
    s_waitcnt lgkmcnt(4)
    v_xor_b32 v164, 0x80008000, v164
    v_xor_b32 v165, 0x80008000, v165
    v_xor_b32 v166, 0x80008000, v166
    v_xor_b32 v167, 0x80008000, v167
    s_setprio 2
    s_mov_b32 s67, 0xa0000000
    s_cmp_lg_u32 s55, 0
    s_cbranch_scc1 L_pr_2
    s_setprio 1
    s_mov_b32 s67, 0x1
L_pr_2:
L_lw_3:
    ds_read_b32 v5, v163 offset:64
    s_waitcnt lgkmcnt(0)
    v_readfirstlane_b32 s6, v5
    s_cmp_lt_u32 s6, 1
    s_cbranch_scc1 L_lw_3
    ds_read_b128 v[8:11], v162 offset:1024
    ds_read_b128 v[12:15], v162
    ds_add_u32 v3, v7 offset:52
    s_waitcnt lgkmcnt(2)
    v_mfma_f32_32x32x16_bf16 v[128:143], v[164:167], v[8:11], 0
    v_mfma_f32_32x32x16_bf16 v[48:63], v[16:19], v[8:11], v[128:143]
    s_waitcnt lgkmcnt(1)
    v_mfma_f32_32x32x16_bf16 v[80:95], v[164:167], v[12:15], 0
    s_nop 7
    s_nop 1
    s_branch L_la
L_gh0:
    s_branch L_ghx
L_tlate:
    s_waitcnt vmcnt(0)
    ds_add_u32 v3, v7 offset:132
L_tl2:
L_lw_4:
    ds_read_b32 v5, v3 offset:44
    s_waitcnt lgkmcnt(0)
    v_readfirstlane_b32 s6, v5
    s_cmp_lt_u32 s6, 6
    s_cbranch_scc1 L_lw_4
L_lw_5:
    ds_read_b32 v5, v3 offset:132
    s_waitcnt lgkmcnt(0)
    v_readfirstlane_b32 s6, v5
    s_cmp_lt_u32 s6, 4
    s_cbranch_scc1 L_lw_5
    buffer_load_dwordx4 v[128:131], v6, s[48:51], s73 offen sc1
    buffer_load_dwordx4 v[132:135], v6, s[48:51], s73 offen offset:1024 sc1
    buffer_load_dwordx4 v[136:139], v6, s[48:51], s73 offen offset:2048 sc1
    buffer_load_dwordx4 v[140:143], v6, s[48:51], s73 offen offset:3072 sc1
    buffer_load_dwordx4 v[80:83], v6, s[48:51], s74 offen sc1
    buffer_load_dwordx4 v[84:87], v6, s[48:51], s74 offen offset:1024 sc1
    buffer_load_dwordx4 v[88:91], v6, s[48:51], s74 offen offset:2048 sc1
    buffer_load_dwordx4 v[92:95], v6, s[48:51], s74 offen offset:3072 sc1
    ds_add_u32 v3, v7 offset:156
    s_branch L_tchk
L_tretry:
    s_sub_u32 s53, s53, 1
    s_cbranch_scc0 L_tr0
    s_mov_b32 s53, 0
    s_branch L_tok
L_tr0:
    s_bitset1_b32 s73, 18
    s_and_b32 s6, s53, 1
    s_cselect_b32 s6, 0, 0x40000
    s_xor_b32 s73, s73, s6
    s_add_u32 s74, s73, 0x1000
    s_waitcnt lgkmcnt(0)
    v_cmp_ne_u32 vcc, s52, v130
    s_cbranch_vccz L_tr1
    buffer_load_dwordx4 v[128:131], v6, s[48:51], s73 offen sc1
L_tr1:
    v_cmp_ne_u32 vcc, s52, v134
    s_cbranch_vccz L_tr2
    buffer_load_dwordx4 v[132:135], v6, s[48:51], s73 offen offset:1024 sc1
L_tr2:
    v_cmp_ne_u32 vcc, s52, v138
    s_cbranch_vccz L_tr3
    buffer_load_dwordx4 v[136:139], v6, s[48:51], s73 offen offset:2048 sc1
L_tr3:
    v_cmp_ne_u32 vcc, s52, v142
    s_cbranch_vccz L_tr4
    buffer_load_dwordx4 v[140:143], v6, s[48:51], s73 offen offset:3072 sc1
L_tr4:
    v_cmp_ne_u32 vcc, s52, v82
    s_cbranch_vccz L_tr5
    buffer_load_dwordx4 v[80:83], v6, s[48:51], s74 offen sc1
L_tr5:
    v_cmp_ne_u32 vcc, s52, v86
    s_cbranch_vccz L_tr6
    buffer_load_dwordx4 v[84:87], v6, s[48:51], s74 offen offset:1024 sc1
L_tr6:
    v_cmp_ne_u32 vcc, s52, v90
    s_cbranch_vccz L_tr7
    buffer_load_dwordx4 v[88:91], v6, s[48:51], s74 offen offset:2048 sc1
L_tr7:
    v_cmp_ne_u32 vcc, s52, v94
    s_cbranch_vccz L_tr8
    buffer_load_dwordx4 v[92:95], v6, s[48:51], s74 offen offset:3072 sc1
L_tr8:
    s_waitcnt vmcnt(0)
    s_branch L_tchk
L_slow:
    v_mov_b32 v46, 0xff800000
    s_mov_b32 s66, 0
L_slow1:
    buffer_load_dwordx4 v[16:19], v6, s[48:51], s66 offen sc1
    s_waitcnt vmcnt(0)
    v_mfma_f32_32x32x16_bf16 v[48:63], v[16:19], v[12:15], 0
    s_add_u32 s66, s66, 0x800
    s_nop 7
    s_nop 3
    v_max3_f32 v46, v46, v48, v49
    v_max3_f32 v46, v46, v50, v51
    v_max3_f32 v46, v46, v52, v53
    v_max3_f32 v46, v46, v54, v55
    v_max3_f32 v46, v46, v56, v57
    v_max3_f32 v46, v46, v58, v59
    v_max3_f32 v46, v46, v60, v61
    v_max3_f32 v46, v46, v62, v63
    s_cmp_lt_u32 s66, 0x20000
    s_cbranch_scc1 L_slow1
    v_mov_b32 v5, v46
    s_nop 1
    v_permlane32_swap_b32 v46, v5
    s_nop 1
    v_max_f32 v46, v46, v5
    s_mov_b32 s66, 0
    v_sub_f32 v128, 0, v46
    v_mov_b32 v112, 0
    v_sub_f32 v129, 0, v46
    v_mov_b32 v113, 0
    v_sub_f32 v130, 0, v46
    v_mov_b32 v114, 0
    v_sub_f32 v131, 0, v46
    v_mov_b32 v115, 0
    v_sub_f32 v132, 0, v46
    v_mov_b32 v116, 0
    v_sub_f32 v133, 0, v46
    v_mov_b32 v117, 0
    v_sub_f32 v134, 0, v46
    v_mov_b32 v118, 0
    v_sub_f32 v135, 0, v46
    v_mov_b32 v119, 0
    v_sub_f32 v136, 0, v46
    v_mov_b32 v120, 0
    v_sub_f32 v137, 0, v46
    v_mov_b32 v121, 0
    v_sub_f32 v138, 0, v46
    v_mov_b32 v122, 0
    v_sub_f32 v139, 0, v46
    v_mov_b32 v123, 0
    v_sub_f32 v140, 0, v46
    v_mov_b32 v124, 0
    v_sub_f32 v141, 0, v46
    v_mov_b32 v125, 0
    v_sub_f32 v142, 0, v46
    v_mov_b32 v126, 0
    v_sub_f32 v143, 0, v46
    v_mov_b32 v127, 0
L_slow2:
    buffer_load_dwordx4 v[16:19], v6, s[48:51], s66 offen sc1
    s_mov_b64 exec, s[64:65]
    buffer_load_dwordx4 v[24:27], v6, s[48:51], s66 offen offset:1024 sc1
    buffer_load_dwordx4 v[28:31], v6, s[48:51], s66 offen offset:1280 sc1
    s_mov_b64 exec, -1
    s_waitcnt vmcnt(0)
    v_mfma_f32_32x32x16_bf16 v[48:63], v[16:19], v[12:15], v[128:143]
    s_add_u32 s66, s66, 0x800
    s_nop 7
    s_nop 3
    v_exp_f32 v48, v48
    v_exp_f32 v49, v49
    v_exp_f32 v50, v50
    v_exp_f32 v51, v51
    v_exp_f32 v52, v52
    v_exp_f32 v53, v53
    v_exp_f32 v54, v54
    v_exp_f32 v55, v55
    v_exp_f32 v56, v56
    v_exp_f32 v57, v57
    v_exp_f32 v58, v58
    v_exp_f32 v59, v59
    v_exp_f32 v60, v60
    v_exp_f32 v61, v61
    v_exp_f32 v62, v62
    v_exp_f32 v63, v63
    s_nop 2
    v_smfmac_f32_32x32x32_bf16 v[112:127], v[24:27], v[48:55], v2
    v_smfmac_f32_32x32x32_bf16 v[112:127], v[28:31], v[56:63], v2
    s_nop 7
    s_nop 7
    s_cmp_lt_u32 s66, 0x20000
    s_cbranch_scc1 L_slow2
    s_nop 7
    v_rcp_f32 v46, v120
    s_nop 0
    s_branch L_norm
.p2align 12
L_g:
    s_waitcnt lgkmcnt(0)
    s_add_u32 s46, s46, s10
    s_addc_u32 s47, s11, 0
    s_load_dwordx2 s[44:45], s[46:47], 0x3c
    s_load_dwordx2 s[44:45], s[46:47], 0x43c
    s_load_dwordx2 s[44:45], s[46:47], 0x83c
    s_load_dwordx2 s[44:45], s[46:47], 0xc3c
    s_barrier
    s_load_dwordx2 s[44:45], s[46:47], 0x2003c
    s_load_dwordx2 s[44:45], s[46:47], 0x2043c
    s_load_dwordx2 s[44:45], s[46:47], 0x2083c
    s_mov_b64 vcc, -1
    s_cmp_eq_u32 s54, 1
    s_cbranch_scc1 L_gh1
    s_cmp_eq_u32 s54, 2
    s_cbranch_scc1 L_gh2
    s_cmp_eq_u32 s54, 3
    s_cbranch_scc1 L_gh3
    s_branch L_gh0
L_ghx:
    s_mov_b32 s64, 0xffff
    s_mov_b32 s65, s64
    v_mov_b32 v2, 0xdddddddd
    v_mov_b32 v4, v3
    v_add_u32 v1, 0, v6
    v_and_b32 v40, 27, v0
    v_mov_b32 v41, 0x3f803f80
    v_cmp_eq_u32 vcc, 16, v40
    v_lshrrev_b32 v161, 5, v0
    v_lshlrev_b32 v161, 9, v161
    v_cndmask_b32 v164, 0, v41, vcc
    v_cndmask_b32 v165, 0, v41, vcc
    s_xor_b32 s7, s54, 0
    s_lshr_b32 s55, s7, 1
    s_lshl_b32 s6, s7, 12
    s_add_u32 s6, s6, 115712
    v_add_u32 v162, s6, v6
    s_lshl_b32 s6, s7, 2
    v_add_u32 v163, s6, v3
    s_and_b32 s6, s7, 1
    s_lshl_b32 s56, s4, 1
    s_add_u32 s56, s56, s6
    s_lshl_b32 s56, s56, 3
    s_add_u32 s56, s56, s5
    s_lshl_b32 s56, s56, 1
    s_add_u32 s56, s56, s55
    s_lshl_b32 s56, s56, 11
    s_add_u32 s56, s56, 0x500400
    v_and_b32 v14, 31, v0
    v_lshrrev_b32 v15, 5, v0
    v_and_b32 v8, 15, v0
    v_xor_b32 v9, v15, v8
    v_lshlrev_b32 v9, 4, v9
    v_lshl_add_u32 v9, v14, 8, v9
    s_and_b32 s6, s54, 1
    s_lshl_b32 s6, s6, 13
    s_add_u32 s6, s6, 16384
    v_add_u32 v40, s6, v9
    v_xor_b32 v41, 32, v40
    v_xor_b32 v42, 64, v40
    v_xor_b32 v43, 96, v40
    v_xor_b32 v44, 128, v40
    v_xor_b32 v45, 160, v40
    v_xor_b32 v46, 192, v40
    v_xor_b32 v47, 224, v40
    v_lshrrev_b32 v9, 2, v8
    v_lshl_add_u32 v14, v15, 3, v9
    v_lshlrev_b32 v14, 7, v14
    v_lshrrev_b32 v15, 3, v8
    v_xor_b32 v15, s55, v15
    v_lshl_add_u32 v14, v15, 6, v14
    v_and_b32 v15, 1, v12
    v_lshl_add_u32 v14, v15, 5, v14
    v_and_b32 v15, 3, v0
    v_lshl_add_u32 v14, v15, 3, v14
    v_add_u32 v160, 81920, v14
    s_load_dwordx2 s[44:45], s[46:47], 0x20c3c
    s_load_dwordx2 s[44:45], s[46:47], 0x4003c
    s_load_dwordx2 s[44:45], s[46:47], 0x4043c
    s_load_dwordx2 s[44:45], s[46:47], 0x4083c
    s_load_dwordx2 s[44:45], s[46:47], 0x40c3c
    s_load_dwordx2 s[44:45], s[46:47], 0x4403c
    s_load_dwordx2 s[44:45], s[46:47], 0x4443c
    s_load_dwordx2 s[44:45], s[46:47], 0x4483c
    s_load_dwordx2 s[44:45], s[46:47], 0x44c3c
    s_mov_b64 vcc, 0
L_lw_6:
    ds_read_b32 v5, v3 offset:136
    s_waitcnt lgkmcnt(0)
    v_readfirstlane_b32 s6, v5
    s_cmp_lt_u32 s6, 8
    s_cbranch_scc1 L_lw_6
    ds_read_b128 v[128:131], v40 offset:0
    ds_read_b128 v[132:135], v41 offset:0
    ds_read_b128 v[136:139], v42 offset:0
    ds_read_b128 v[140:143], v43 offset:0
    ds_read_b128 v[144:147], v44 offset:0
    ds_read_b128 v[148:151], v45 offset:0
    ds_read_b128 v[152:155], v46 offset:0
    ds_read_b128 v[156:159], v47 offset:0
    ds_read_b128 v[96:99], v40 offset:16384
    ds_read_b128 v[100:103], v41 offset:16384
    ds_read_b128 v[104:107], v42 offset:16384
    ds_read_b128 v[108:111], v43 offset:16384
    ds_read_b128 v[112:115], v44 offset:16384
    ds_read_b128 v[116:119], v45 offset:16384
    ds_read_b128 v[120:123], v46 offset:16384
    s_waitcnt lgkmcnt(13)
    ds_read_b128 v[124:127], v47 offset:16384
    ds_read_b128 v[8:11], v40 offset:32768
    s_waitcnt lgkmcnt(13)
    ds_read_b128 v[12:15], v41 offset:32768
    ds_read_b128 v[16:19], v42 offset:32768
    s_waitcnt lgkmcnt(13)
    ds_read_b128 v[20:23], v43 offset:32768
    ds_read_b32 v5, v3 offset:120
    s_waitcnt lgkmcnt(13)
    ds_read_b128 v[24:27], v44 offset:32768
    ds_read_b128 v[28:31], v45 offset:32768
    s_waitcnt lgkmcnt(13)
    ds_read_b128 v[32:35], v46 offset:32768
    ds_read_b128 v[36:39], v47 offset:32768
    s_waitcnt lgkmcnt(13)
    ds_add_u32 v3, v7 offset:140
    s_waitcnt lgkmcnt(5)
    v_readfirstlane_b32 s6, v5
    s_cmp_lt_u32 s6, 4
    s_cbranch_scc1 L_gs0
L_gr0:
    ds_read_b64_tr_b16 v[48:49], v160 offset:0
    ds_read_b64_tr_b16 v[50:51], v160 offset:512
    ds_read_b64_tr_b16 v[52:53], v160 offset:2048
    ds_read_b64_tr_b16 v[54:55], v160 offset:2560
    ds_read_b64_tr_b16 v[56:57], v160 offset:4096
    ds_read_b64_tr_b16 v[58:59], v160 offset:4608
    ds_read_b64_tr_b16 v[60:61], v160 offset:6144
    ds_read_b64_tr_b16 v[62:63], v160 offset:6656
    ds_read_b64_tr_b16 v[64:65], v160 offset:8192
    ds_read_b64_tr_b16 v[66:67], v160 offset:8704
    s_waitcnt lgkmcnt(13)
    ds_read_b64_tr_b16 v[68:69], v160 offset:10240
    ds_read_b64_tr_b16 v[70:71], v160 offset:10752
    s_waitcnt lgkmcnt(13)
    ds_read_b64_tr_b16 v[72:73], v160 offset:12288
    ds_read_b64_tr_b16 v[74:75], v160 offset:12800
    s_waitcnt lgkmcnt(13)
    ds_read_b64_tr_b16 v[76:77], v160 offset:14336
    ds_read_b64_tr_b16 v[78:79], v160 offset:14848
    s_waitcnt lgkmcnt(13)
    ds_read_b32 v5, v3 offset:124
    v_mfma_f32_32x32x16_bf16 v[80:95], v[48:51], v[128:131], 0
    s_waitcnt lgkmcnt(13)
    v_mfma_f32_32x32x16_bf16 v[80:95], v[52:55], v[132:135], v[80:95]
    s_waitcnt lgkmcnt(11)
    v_mfma_f32_32x32x16_bf16 v[80:95], v[56:59], v[136:139], v[80:95]
    s_waitcnt lgkmcnt(9)
    v_mfma_f32_32x32x16_bf16 v[80:95], v[60:63], v[140:143], v[80:95]
    s_waitcnt lgkmcnt(0)
    v_readfirstlane_b32 s6, v5
    s_cmp_lt_u32 s6, 4
    s_cbranch_scc1 L_gs1
L_gr1:
    v_mfma_f32_32x32x16_bf16 v[80:95], v[64:67], v[144:147], v[80:95]
    ds_read_b64_tr_b16 v[48:49], v160 offset:16384
    ds_read_b64_tr_b16 v[50:51], v160 offset:16896
    ds_read_b64_tr_b16 v[52:53], v160 offset:18432
    ds_read_b64_tr_b16 v[54:55], v160 offset:18944
    v_mfma_f32_32x32x16_bf16 v[80:95], v[68:71], v[148:151], v[80:95]
    ds_read_b64_tr_b16 v[56:57], v160 offset:20480
    ds_read_b64_tr_b16 v[58:59], v160 offset:20992
    ds_read_b64_tr_b16 v[60:61], v160 offset:22528
    ds_read_b64_tr_b16 v[62:63], v160 offset:23040
    v_mfma_f32_32x32x16_bf16 v[80:95], v[72:75], v[152:155], v[80:95]
    ds_read_b64_tr_b16 v[64:65], v160 offset:24576
    ds_read_b64_tr_b16 v[66:67], v160 offset:25088
    ds_read_b64_tr_b16 v[68:69], v160 offset:26624
    ds_read_b64_tr_b16 v[70:71], v160 offset:27136
L_gh1:
    s_cbranch_vccnz L_ghx
    v_mfma_f32_32x32x16_bf16 v[80:95], v[76:79], v[156:159], v[80:95]
    ds_read_b64_tr_b16 v[72:73], v160 offset:28672
    ds_read_b64_tr_b16 v[74:75], v160 offset:29184
    ds_read_b64_tr_b16 v[76:77], v160 offset:30720
    s_waitcnt lgkmcnt(13)
    ds_read_b64_tr_b16 v[78:79], v160 offset:31232
    ds_read_b32 v5, v3 offset:128
    v_mfma_f32_32x32x16_bf16 v[80:95], v[48:51], v[96:99], v[80:95]
    s_waitcnt lgkmcnt(13)
    ds_read_b128 v[128:131], v40 offset:49152
    ds_read_b128 v[132:135], v41 offset:49152
    v_mfma_f32_32x32x16_bf16 v[80:95], v[52:55], v[100:103], v[80:95]
    s_waitcnt lgkmcnt(13)
    ds_read_b128 v[136:139], v42 offset:49152
    ds_read_b128 v[140:143], v43 offset:49152
    v_mfma_f32_32x32x16_bf16 v[80:95], v[56:59], v[104:107], v[80:95]
    s_waitcnt lgkmcnt(13)
    ds_read_b128 v[144:147], v44 offset:49152
    ds_read_b128 v[148:151], v45 offset:49152
    v_mfma_f32_32x32x16_bf16 v[80:95], v[60:63], v[108:111], v[80:95]
    s_waitcnt lgkmcnt(13)
    ds_read_b128 v[152:155], v46 offset:49152
    ds_read_b128 v[156:159], v47 offset:49152
    s_waitcnt lgkmcnt(8)
    v_readfirstlane_b32 s6, v5
    s_cmp_lt_u32 s6, 4
    s_cbranch_scc1 L_gs2
L_gr2:
    v_mfma_f32_32x32x16_bf16 v[80:95], v[64:67], v[112:115], v[80:95]
    ds_read_b64_tr_b16 v[48:49], v160 offset:48128
    ds_read_b64_tr_b16 v[50:51], v160 offset:48640
    ds_read_b64_tr_b16 v[52:53], v160 offset:50176
    ds_read_b64_tr_b16 v[54:55], v160 offset:50688
    v_mfma_f32_32x32x16_bf16 v[80:95], v[68:71], v[116:119], v[80:95]
    ds_read_b64_tr_b16 v[56:57], v160 offset:52224
    ds_read_b64_tr_b16 v[58:59], v160 offset:52736
    ds_read_b64_tr_b16 v[60:61], v160 offset:54272
    s_waitcnt lgkmcnt(13)
    ds_read_b64_tr_b16 v[62:63], v160 offset:54784
    v_mfma_f32_32x32x16_bf16 v[80:95], v[72:75], v[120:123], v[80:95]
    ds_read_b64_tr_b16 v[64:65], v160 offset:56320
    s_waitcnt lgkmcnt(13)
    ds_read_b64_tr_b16 v[66:67], v160 offset:56832
    ds_read_b64_tr_b16 v[68:69], v160 offset:58368
    s_waitcnt lgkmcnt(13)
    ds_read_b64_tr_b16 v[70:71], v160 offset:58880
    v_mfma_f32_32x32x16_bf16 v[80:95], v[76:79], v[124:127], v[80:95]
    ds_read_b64_tr_b16 v[72:73], v160 offset:60416
    s_waitcnt lgkmcnt(13)
    ds_read_b64_tr_b16 v[74:75], v160 offset:60928
    ds_read_b64_tr_b16 v[76:77], v160 offset:62464
    s_waitcnt lgkmcnt(13)
    ds_read_b64_tr_b16 v[78:79], v160 offset:62976
    ds_read_b32 v5, v3 offset:132
    v_mfma_f32_32x32x16_bf16 v[80:95], v[48:51], v[8:11], v[80:95]
    v_mov_b64 v[96:97], 0
    v_mov_b64 v[98:99], 0
    v_mov_b64 v[100:101], 0
    v_mov_b64 v[102:103], 0
    v_mov_b64 v[104:105], 0
    s_waitcnt lgkmcnt(13)
    v_mfma_f32_32x32x16_bf16 v[80:95], v[52:55], v[12:15], v[80:95]
    v_mov_b64 v[106:107], 0
    v_mov_b64 v[108:109], 0
    v_mov_b64 v[110:111], 0
    v_mov_b64 v[112:113], 0
    v_mov_b64 v[114:115], 0
    s_waitcnt lgkmcnt(11)
    v_mfma_f32_32x32x16_bf16 v[80:95], v[56:59], v[16:19], v[80:95]
    v_mov_b64 v[116:117], 0
    v_mov_b64 v[118:119], 0
    v_mov_b64 v[120:121], 0
    v_mov_b64 v[122:123], 0
    v_mov_b64 v[124:125], 0
    s_waitcnt lgkmcnt(9)
    v_mfma_f32_32x32x16_bf16 v[80:95], v[60:63], v[20:23], v[80:95]
    v_add_u32 v160, 64512, v160
    s_waitcnt lgkmcnt(0)
    v_readfirstlane_b32 s6, v5
    s_cmp_lt_u32 s6, 4
    s_cbranch_scc1 L_gs3
L_gr3:
    v_mov_b64 v[126:127], 0
    v_mfma_f32_32x32x16_bf16 v[80:95], v[64:67], v[24:27], v[80:95]
    ds_read_b64_tr_b16 v[48:49], v160 offset:0
    ds_read_b64_tr_b16 v[50:51], v160 offset:512
    ds_read_b64_tr_b16 v[52:53], v160 offset:2048
    ds_read_b64_tr_b16 v[54:55], v160 offset:2560
    v_lshl_add_u32 v40, s3, 11, v6
    v_mfma_f32_32x32x16_bf16 v[80:95], v[68:71], v[28:31], v[80:95]
    ds_read_b64_tr_b16 v[56:57], v160 offset:4096
    ds_read_b64_tr_b16 v[58:59], v160 offset:4608
    ds_read_b64_tr_b16 v[60:61], v160 offset:6144
    ds_read_b64_tr_b16 v[62:63], v160 offset:6656
    v_xor_b32 v41, 0x3000, v40
    v_mfma_f32_32x32x16_bf16 v[80:95], v[72:75], v[32:35], v[80:95]
    ds_read_b64_tr_b16 v[64:65], v160 offset:8192
    ds_read_b64_tr_b16 v[66:67], v160 offset:8704
    ds_read_b64_tr_b16 v[68:69], v160 offset:10240
    ds_read_b64_tr_b16 v[70:71], v160 offset:10752
    v_lshrrev_b32 v42, 3, v40
    v_mfma_f32_32x32x16_bf16 v[80:95], v[76:79], v[36:39], v[80:95]
    ds_read_b64_tr_b16 v[72:73], v160 offset:12288
    ds_read_b64_tr_b16 v[74:75], v160 offset:12800
    ds_read_b64_tr_b16 v[76:77], v160 offset:14336
    s_waitcnt lgkmcnt(13)
    ds_read_b64_tr_b16 v[78:79], v160 offset:14848
    v_lshl_add_u32 v42, v0, 1, v42
    v_mfma_f32_32x32x16_bf16 v[80:95], v[48:51], v[128:131], v[80:95]
    ds_add_u32 v3, v7 offset:152
    v_xor_b32 v43, 0x600, v42
    v_add_u32 v42, 160256, v42
    v_add_u32 v43, 160256, v43
L_gh2:
    s_cbranch_vccnz L_ghx
    s_waitcnt lgkmcnt(13)
    v_mfma_f32_32x32x16_bf16 v[80:95], v[52:55], v[132:135], v[80:95]
    v_lshl_add_u32 v44, s3, 2, v3
    v_xor_b32 v45, 24, v44
    v_lshl_add_u32 v47, s55, 3, v3
    s_waitcnt lgkmcnt(11)
    v_mfma_f32_32x32x16_bf16 v[80:95], v[56:59], v[136:139], v[80:95]
    v_mov_b64 v[24:25], v[164:165]
    v_mov_b64 v[26:27], v[164:165]
    s_waitcnt lgkmcnt(9)
    v_mfma_f32_32x32x16_bf16 v[80:95], v[60:63], v[140:143], v[80:95]
    v_mov_b64 v[28:29], v[164:165]
    v_mov_b64 v[30:31], v[164:165]
    s_waitcnt lgkmcnt(7)
    v_mfma_f32_32x32x16_bf16 v[80:95], v[64:67], v[144:147], v[80:95]
    v_mov_b64 v[32:33], v[164:165]
    v_mov_b64 v[34:35], v[164:165]
    ds_read_b32 v5, v3 offset:56
    s_waitcnt lgkmcnt(6)
    v_mfma_f32_32x32x16_bf16 v[80:95], v[68:71], v[148:151], v[80:95]
    v_mov_b64 v[36:37], v[164:165]
    s_waitcnt lgkmcnt(4)
    v_mfma_f32_32x32x16_bf16 v[80:95], v[72:75], v[152:155], v[80:95]
    v_mov_b64 v[38:39], v[164:165]
    s_waitcnt lgkmcnt(2)
    v_mfma_f32_32x32x16_bf16 v[80:95], v[76:79], v[156:159], v[80:95]
    s_waitcnt vmcnt(0)
    s_waitcnt lgkmcnt(0)
    v_readfirstlane_b32 s6, v5
    s_cmp_lt_u32 s6, 4
    s_cbranch_scc1 L_qlate
    ds_read_b128 v[164:167], v161 offset:0
    ds_read_b128 v[16:19], v1 offset:0
    s_mov_b64 exec, s[64:65]
    ds_read_b128 v[24:27], v1 offset:1024
    ds_read_b128 v[28:31], v1 offset:1280
    s_mov_b64 exec, -1
    ds_read_b128 v[20:23], v1 offset:4096
    s_nop 1
    v_cvt_pk_bf16_f32 v8, v80, v81
    v_cvt_pk_bf16_f32 v9, v82, v83
    v_cvt_pk_bf16_f32 v10, v84, v85
    v_cvt_pk_bf16_f32 v11, v86, v87
    v_cvt_pk_bf16_f32 v12, v88, v89
    v_cvt_pk_bf16_f32 v13, v90, v91
    v_cvt_pk_bf16_f32 v14, v92, v93
    v_cvt_pk_bf16_f32 v15, v94, v95
    ds_write_b128 v162, v[8:11]
    ds_write_b128 v162, v[12:15] offset:1024
    ds_add_u32 v163, v7 offset:64
    v_mov_b64 v[72:73], 0
    v_mov_b64 v[74:75], 0
    v_mov_b64 v[76:77], 0
    v_mov_b64 v[78:79], 0
    s_mov_b32 s66, 0
    s_mov_b32 s69, 0x5d800000
    s_waitcnt lgkmcnt(7)
    v_xor_b32 v164, 0x80008000, v164
    v_xor_b32 v165, 0x80008000, v165
    v_xor_b32 v166, 0x80008000, v166
    v_xor_b32 v167, 0x80008000, v167
    s_waitcnt lgkmcnt(6)
L_gst:
    s_setprio 2
    s_mov_b32 s67, 0xa0000000
    s_cmp_lg_u32 s55, 0
    s_cbranch_scc1 L_pr_7
    s_setprio 1
    s_mov_b32 s67, 0x1
L_pr_7:
    v_mfma_f32_32x32x16_bf16 v[128:143], v[164:167], v[8:11], 0
    v_mfma_f32_32x32x16_bf16 v[48:63], v[16:19], v[8:11], v[128:143]
    v_mfma_f32_32x32x16_bf16 v[80:95], v[164:167], v[12:15], 0
    s_waitcnt lgkmcnt(0)
    s_nop 7
    s_nop 0
    s_branch L_la
L_qlate:
    s_nop 7
    v_cvt_pk_bf16_f32 v8, v80, v81
    v_cvt_pk_bf16_f32 v9, v82, v83
    v_cvt_pk_bf16_f32 v10, v84, v85
    v_cvt_pk_bf16_f32 v11, v86, v87
    v_cvt_pk_bf16_f32 v12, v88, v89
    v_cvt_pk_bf16_f32 v13, v90, v91
    v_cvt_pk_bf16_f32 v14, v92, v93
    v_cvt_pk_bf16_f32 v15, v94, v95
    ds_write_b128 v162, v[8:11]
    ds_write_b128 v162, v[12:15] offset:1024
    ds_add_u32 v163, v7 offset:64
    v_mov_b64 v[72:73], 0
    v_mov_b64 v[74:75], 0
    v_mov_b64 v[76:77], 0
    v_mov_b64 v[78:79], 0
L_lw_8:
    ds_read_b32 v5, v3 offset:56
    s_waitcnt lgkmcnt(0)
    v_readfirstlane_b32 s6, v5
    s_cmp_lt_u32 s6, 4
    s_cbranch_scc1 L_lw_8
    ds_read_b128 v[164:167], v161 offset:0
    ds_read_b128 v[16:19], v1 offset:0
    s_mov_b64 exec, s[64:65]
    ds_read_b128 v[24:27], v1 offset:1024
    ds_read_b128 v[28:31], v1 offset:1280
    s_mov_b64 exec, -1
    ds_read_b128 v[20:23], v1 offset:4096
    s_mov_b32 s66, 0
    s_mov_b32 s69, 0x5d800000
    s_waitcnt lgkmcnt(4)
    v_xor_b32 v164, 0x80008000, v164
    v_xor_b32 v165, 0x80008000, v165
    v_xor_b32 v166, 0x80008000, v166
    v_xor_b32 v167, 0x80008000, v167
    s_waitcnt lgkmcnt(3)
    s_branch L_gst
L_gs0:
L_lw_9:
    ds_read_b32 v5, v3 offset:120
    s_waitcnt lgkmcnt(0)
    v_readfirstlane_b32 s6, v5
    s_cmp_lt_u32 s6, 4
    s_cbranch_scc1 L_lw_9
    s_branch L_gr0
L_gs1:
L_lw_10:
    ds_read_b32 v5, v3 offset:124
    s_waitcnt lgkmcnt(0)
    v_readfirstlane_b32 s6, v5
    s_cmp_lt_u32 s6, 4
    s_cbranch_scc1 L_lw_10
    s_branch L_gr1
L_gs2:
L_lw_11:
    ds_read_b32 v5, v3 offset:128
    s_waitcnt lgkmcnt(0)
    v_readfirstlane_b32 s6, v5
    s_cmp_lt_u32 s6, 4
    s_cbranch_scc1 L_lw_11
    s_branch L_gr2
L_gs3:
L_lw_12:
    ds_read_b32 v5, v3 offset:132
    s_waitcnt lgkmcnt(0)
    v_readfirstlane_b32 s6, v5
    s_cmp_lt_u32 s6, 4
    s_cbranch_scc1 L_lw_12
    s_branch L_gr3
L_lspin:
    s_sleep 1
    ds_read_b32 v5, v4
    s_waitcnt lgkmcnt(0)
    v_readfirstlane_b32 s6, v5
    s_branch L_lchk
L_gh3:
    s_cbranch_vccnz L_ghx
L_lsw:
    s_setprio 0
    s_branch L_lsr
.p2align 6
L_lb:
    v_add_u32 v1, 0x4000, v1
    s_cmp_eq_u32 s66, s67
    s_cbranch_scc1 L_lsw
L_lsr:
L_la:
    v_exp_f32 v48, v48
    v_exp_f32 v49, v49
    v_smfmac_f32_32x32x32_bf16 v[112:127], v[36:39], v[72:79], v2
    v_exp_f32 v50, v50
    v_exp_f32 v51, v51
    v_exp_f32 v52, v52
    v_exp_f32 v53, v53
    v_exp_f32 v54, v54
    v_mfma_f32_32x32x16_bf16 v[64:79], v[16:19], v[12:15], v[80:95]
    s_mov_b64 exec, s[64:65]
    ds_read_b128 v[32:35], v1 offset:5120
    ds_read_b128 v[36:39], v1 offset:5376
    s_mov_b64 exec, -1
    ds_read_b128 v[16:19], v1 offset:8192
    v_exp_f32 v55, v55
    v_exp_f32 v56, v56
    v_exp_f32 v57, v57
    v_exp_f32 v58, v58
    v_exp_f32 v59, v59
    s_waitcnt lgkmcnt(3)
    v_smfmac_f32_32x32x32_bf16 v[96:111], v[24:27], v[48:55], v2
    v_exp_f32 v60, v60
    v_exp_f32 v61, v61
    v_exp_f32 v62, v62
    v_exp_f32 v63, v63
    v_exp_f32 v64, v64
    v_exp_f32 v65, v65
    v_smfmac_f32_32x32x32_bf16 v[96:111], v[28:31], v[56:63], v2
    v_exp_f32 v66, v66
    v_exp_f32 v67, v67
    v_exp_f32 v68, v68
    v_exp_f32 v69, v69
    v_exp_f32 v70, v70
    v_mfma_f32_32x32x16_bf16 v[48:63], v[20:23], v[8:11], v[128:143]
    v_exp_f32 v71, v71
    v_exp_f32 v72, v72
    v_exp_f32 v73, v73
    v_exp_f32 v74, v74
    v_exp_f32 v75, v75
    v_smfmac_f32_32x32x32_bf16 v[112:127], v[24:27], v[64:71], v2
    v_exp_f32 v76, v76
    v_exp_f32 v77, v77
    v_exp_f32 v78, v78
    v_exp_f32 v79, v79
    v_exp_f32 v48, v48
    v_exp_f32 v49, v49
    v_smfmac_f32_32x32x32_bf16 v[112:127], v[28:31], v[72:79], v2
    v_exp_f32 v50, v50
    v_exp_f32 v51, v51
    v_exp_f32 v52, v52
    v_exp_f32 v53, v53
    v_exp_f32 v54, v54
    v_mfma_f32_32x32x16_bf16 v[64:79], v[20:23], v[12:15], v[80:95]
    s_mov_b64 exec, s[64:65]
    ds_read_b128 v[24:27], v1 offset:9216
    ds_read_b128 v[28:31], v1 offset:9472
    s_mov_b64 exec, -1
    ds_read_b128 v[20:23], v1 offset:12288
    ds_read_b32 v5, v4
    v_exp_f32 v55, v55
    v_exp_f32 v56, v56
    v_exp_f32 v57, v57
    v_exp_f32 v58, v58
    v_exp_f32 v59, v59
    s_waitcnt lgkmcnt(4)
    v_smfmac_f32_32x32x32_bf16 v[96:111], v[32:35], v[48:55], v2
    v_exp_f32 v60, v60
    v_exp_f32 v61, v61
    v_exp_f32 v62, v62
    v_exp_f32 v63, v63
    v_exp_f32 v64, v64
    v_exp_f32 v65, v65
    v_smfmac_f32_32x32x32_bf16 v[96:111], v[36:39], v[56:63], v2
    v_exp_f32 v66, v66
    v_exp_f32 v67, v67
    v_exp_f32 v68, v68
    v_exp_f32 v69, v69
    v_exp_f32 v70, v70
    v_mfma_f32_32x32x16_bf16 v[48:63], v[16:19], v[8:11], v[128:143]
    v_exp_f32 v71, v71
    v_exp_f32 v72, v72
    v_exp_f32 v73, v73
    v_exp_f32 v74, v74
    v_exp_f32 v75, v75
    v_smfmac_f32_32x32x32_bf16 v[112:127], v[32:35], v[64:71], v2
    s_waitcnt lgkmcnt(0)
    v_readfirstlane_b32 s6, v5
    ds_add_u32 v4, v7 offset:8
    v_exp_f32 v76, v76
    v_exp_f32 v77, v77
    v_exp_f32 v78, v78
    v_exp_f32 v79, v79
L_lchk:
    s_cmp_lt_u32 s6, 64
    s_cbranch_scc1 L_lspin
    v_add_u32 v4, 4, v4
    s_add_u32 s66, s66, 0x20000000
    v_exp_f32 v48, v48
    v_exp_f32 v49, v49
    v_smfmac_f32_32x32x32_bf16 v[112:127], v[36:39], v[72:79], v2
    v_exp_f32 v50, v50
    v_exp_f32 v51, v51
    v_exp_f32 v52, v52
    v_exp_f32 v53, v53
    v_exp_f32 v54, v54
    v_mfma_f32_32x32x16_bf16 v[64:79], v[16:19], v[12:15], v[80:95]
    s_mov_b64 exec, s[64:65]
    ds_read_b128 v[32:35], v1 offset:13312
    ds_read_b128 v[36:39], v1 offset:13568
    s_mov_b64 exec, -1
    ds_read_b128 v[16:19], v1 offset:16384
    v_exp_f32 v55, v55
    v_exp_f32 v56, v56
    v_exp_f32 v57, v57
    v_exp_f32 v58, v58
    v_exp_f32 v59, v59
    s_waitcnt lgkmcnt(3)
    v_smfmac_f32_32x32x32_bf16 v[96:111], v[24:27], v[48:55], v2
    v_exp_f32 v60, v60
    v_exp_f32 v61, v61
    v_exp_f32 v62, v62
    v_exp_f32 v63, v63
    v_exp_f32 v64, v64
    v_exp_f32 v65, v65
    v_smfmac_f32_32x32x32_bf16 v[96:111], v[28:31], v[56:63], v2
    v_exp_f32 v66, v66
    v_exp_f32 v67, v67
    v_exp_f32 v68, v68
    v_exp_f32 v69, v69
    v_exp_f32 v70, v70
    v_mfma_f32_32x32x16_bf16 v[48:63], v[20:23], v[8:11], v[128:143]
    v_exp_f32 v71, v71
    v_exp_f32 v72, v72
    v_exp_f32 v73, v73
    v_exp_f32 v74, v74
    v_exp_f32 v75, v75
    v_smfmac_f32_32x32x32_bf16 v[112:127], v[24:27], v[64:71], v2
    v_exp_f32 v76, v76
    v_exp_f32 v77, v77
    v_exp_f32 v78, v78
    v_exp_f32 v79, v79
    v_exp_f32 v48, v48
    v_exp_f32 v49, v49
    v_smfmac_f32_32x32x32_bf16 v[112:127], v[28:31], v[72:79], v2
    v_exp_f32 v50, v50
    v_exp_f32 v51, v51
    v_exp_f32 v52, v52
    v_exp_f32 v53, v53
    v_exp_f32 v54, v54
    v_mfma_f32_32x32x16_bf16 v[64:79], v[20:23], v[12:15], v[80:95]
    s_mov_b64 exec, s[64:65]
    ds_read_b128 v[24:27], v1 offset:17408
    ds_read_b128 v[28:31], v1 offset:17664
    s_mov_b64 exec, -1
    ds_read_b128 v[20:23], v1 offset:20480
    v_exp_f32 v55, v55
    v_exp_f32 v56, v56
    v_exp_f32 v57, v57
    v_exp_f32 v58, v58
    v_exp_f32 v59, v59
    s_waitcnt lgkmcnt(3)
    v_smfmac_f32_32x32x32_bf16 v[96:111], v[32:35], v[48:55], v2
    v_exp_f32 v60, v60
    v_exp_f32 v61, v61
    v_exp_f32 v62, v62
    v_exp_f32 v63, v63
    v_exp_f32 v64, v64
    v_exp_f32 v65, v65
    v_smfmac_f32_32x32x32_bf16 v[96:111], v[36:39], v[56:63], v2
    v_exp_f32 v66, v66
    v_exp_f32 v67, v67
    v_exp_f32 v68, v68
    v_exp_f32 v69, v69
    v_exp_f32 v70, v70
    v_mfma_f32_32x32x16_bf16 v[48:63], v[16:19], v[8:11], v[128:143]
    v_exp_f32 v71, v71
    v_exp_f32 v72, v72
    v_exp_f32 v73, v73
    v_exp_f32 v74, v74
    v_exp_f32 v75, v75
    v_smfmac_f32_32x32x32_bf16 v[112:127], v[32:35], v[64:71], v2
    v_exp_f32 v76, v76
    v_exp_f32 v77, v77
    v_exp_f32 v78, v78
    v_exp_f32 v79, v79
    s_cbranch_scc0 L_lb
    s_setprio 3
    s_cmp_lg_u32 s6, 72
    v_smfmac_f32_32x32x32_bf16 v[112:127], v[36:39], v[72:79], v2
    s_cbranch_scc1 L_cwait
L_cok:
    ds_write_b128 v40, v[96:99]
    ds_write_b128 v40, v[100:103] offset:1024
    ds_write_b32 v42, v104
    ds_add_u32 v44, v7 offset:160
L_crd:
    ds_read_b32 v5, v45 offset:160
    ds_read_b32 v56, v43
    ds_read_b32 v57, v3 offset:40
    ds_read_b128 v[48:51], v41
    ds_read_b128 v[52:55], v41 offset:1024
    s_waitcnt lgkmcnt(4)
    v_readfirstlane_b32 s6, v5
    s_cmp_eq_u32 s6, 0
    s_cbranch_scc1 L_cfail
    s_waitcnt lgkmcnt(2)
    v_add_f32 v120, v120, v56
    v_readfirstlane_b32 s71, v57
    v_rcp_f32 v46, v120
    v_cmp_ngt_f32 vcc, s69, v120
    s_waitcnt lgkmcnt(0)
    v_pk_add_f32 v[112:113], v[112:113], v[48:49]
    v_pk_add_f32 v[114:115], v[114:115], v[50:51]
    v_pk_add_f32 v[116:117], v[116:117], v[52:53]
    v_pk_add_f32 v[118:119], v[118:119], v[54:55]
    s_cbranch_vccnz L_slow
L_norm:
    v_pk_mul_f32 v[112:113], v[112:113], v[46:47] op_sel_hi:[1,0]
    v_pk_mul_f32 v[114:115], v[114:115], v[46:47] op_sel_hi:[1,0]
    v_pk_mul_f32 v[116:117], v[116:117], v[46:47] op_sel_hi:[1,0]
    v_pk_mul_f32 v[118:119], v[118:119], v[46:47] op_sel_hi:[1,0]
    v_cvt_pk_bf16_f32 v48, v112, v113
    v_cvt_pk_bf16_f32 v49, v114, v115
    v_cvt_pk_bf16_f32 v50, v116, v117
    v_cvt_pk_bf16_f32 v51, v118, v119
    s_cmp_lg_u32 s71, 2
    v_min_u32 v48, -2, v48
    v_min_u32 v49, -2, v49
    v_min_u32 v50, -2, v50
    v_min_u32 v51, -2, v51
    s_cbranch_scc1 L_ost1
    buffer_store_dwordx4 v[48:51], v6, s[48:51], s56 offen
L_ost2:
    ds_write_b128 v41, v[48:51]
    ds_add_u32 v47, v7 offset:96
    s_endpgm
L_ost1:
L_lw_13:
    ds_read_b32 v5, v3 offset:40
    s_waitcnt lgkmcnt(0)
    v_readfirstlane_b32 s6, v5
    s_cmp_lt_u32 s6, 1
    s_cbranch_scc1 L_lw_13
    buffer_store_dwordx4 v[48:51], v6, s[48:51], s56 offen sc1
    s_branch L_ost2
L_cwait:
    s_branch L_lv_15
L_lw_14:
    s_sleep 4
L_lv_15:
    ds_read_b32 v5, v3 offset:12
    s_waitcnt lgkmcnt(0)
    v_readfirstlane_b32 s6, v5
    s_cmp_lt_u32 s6, 72
    s_cbranch_scc1 L_lw_14
    s_branch L_cok
L_cfail:
    s_cmp_lg_u32 s55, 0
    s_cbranch_scc1 L_crd
    s_sleep 4
    s_branch L_crd
.p2align 12
L_oh0:
    s_branch L_ohx
L_out:
    v_lshlrev_b32 v6, 4, v0
    s_setprio 3
    ds_read_b32 v24, v3 offset:108
    v_lshrrev_b32 v8, 4, v0
    v_and_b32 v9, 15, v0
    s_lshr_b32 s6, s54, 1
    v_and_b32 v10, 1, v8
    v_lshrrev_b32 v11, 1, v8
    s_lshl1_add_u32 s56, s4, s6
    v_lshrrev_b32 v12, 2, v9
    v_and_b32 v14, 3, v0
    s_and_b32 s7, s54, 1
    v_lshl_add_u32 v12, v10, 2, v12
    v_and_b32 v1, 0x300, v6
    s_lshl_b32 s56, s56, 7
    v_lshrrev_b32 v13, 1, v12
    v_lshl_add_u32 v12, v11, 4, v12
    s_add_u32 s56, s56, s7
    v_lshlrev_b32 v12, 7, v12
    v_lshlrev_b32 v14, 3, v14
    s_lshl_b32 s56, s56, 8
    v_lshl_add_u32 v12, v13, 5, v12
    s_add_u32 s56, s56, 0x500000
    s_movk_i32 s57, 16384
    v_add3_u32 v1, v1, v6, s56
    v_add3_u32 v6, v12, v14, s57
    s_lshl3_add_u32 s6, s6, s7
    s_lshl_b32 s56, s5, 12
    v_xor_b32 v0, 32, v6
    v_xor_b32 v5, 64, v6
    v_xor_b32 v7, 0x60, v6
    s_lshl_b32 s64, s6, 8
    s_waitcnt lgkmcnt(0)
    v_readfirstlane_b32 s6, v24
    s_cmp_lt_u32 s6, 4
    s_cbranch_scc1 L_oww
L_owk:
    ds_read_b64_tr_b16 v[56:57], v6 offset:0
    ds_read_b64_tr_b16 v[58:59], v6 offset:1024
    ds_read_b64_tr_b16 v[60:61], v0 offset:0
    ds_read_b64_tr_b16 v[62:63], v0 offset:1024
    ds_read_b64_tr_b16 v[64:65], v5 offset:0
    ds_read_b64_tr_b16 v[66:67], v5 offset:1024
    ds_read_b64_tr_b16 v[68:69], v7 offset:0
    ds_read_b64_tr_b16 v[70:71], v7 offset:1024
    s_add_u32 s57, s56, 0x1000
    s_and_b32 s57, s57, 0x7000
    ds_read_b64_tr_b16 v[72:73], v6 offset:4096
    ds_read_b64_tr_b16 v[74:75], v6 offset:5120
    ds_read_b64_tr_b16 v[76:77], v0 offset:4096
    ds_read_b64_tr_b16 v[78:79], v0 offset:5120
    ds_read_b64_tr_b16 v[80:81], v5 offset:4096
    ds_read_b64_tr_b16 v[82:83], v5 offset:5120
    ds_read_b64_tr_b16 v[84:85], v7 offset:4096
    ds_read_b64_tr_b16 v[86:87], v7 offset:5120
    s_add_u32 s58, s57, 0x1000
    s_and_b32 s58, s58, 0x7000
    ds_read_b64_tr_b16 v[88:89], v6 offset:8192
    ds_read_b64_tr_b16 v[90:91], v6 offset:9216
    ds_read_b64_tr_b16 v[92:93], v0 offset:8192
    ds_read_b64_tr_b16 v[94:95], v0 offset:9216
    ds_read_b64_tr_b16 v[96:97], v5 offset:8192
    ds_read_b64_tr_b16 v[98:99], v5 offset:9216
    ds_read_b64_tr_b16 v[100:101], v7 offset:8192
    ds_read_b64_tr_b16 v[102:103], v7 offset:9216
    s_add_u32 s59, s58, 0x1000
    s_and_b32 s59, s59, 0x7000
    ds_read_b64_tr_b16 v[104:105], v6 offset:12288
    ds_read_b64_tr_b16 v[106:107], v6 offset:13312
    ds_read_b64_tr_b16 v[108:109], v0 offset:12288
    ds_read_b64_tr_b16 v[110:111], v0 offset:13312
    ds_read_b64_tr_b16 v[112:113], v5 offset:12288
    ds_read_b64_tr_b16 v[114:115], v5 offset:13312
    ds_read_b64_tr_b16 v[116:117], v7 offset:12288
    ds_read_b64_tr_b16 v[118:119], v7 offset:13312
    s_add_u32 s60, s59, 0x1000
    s_and_b32 s60, s60, 0x7000
    ds_read_b64_tr_b16 v[120:121], v6 offset:16384
    ds_read_b64_tr_b16 v[122:123], v6 offset:17408
    ds_read_b64_tr_b16 v[124:125], v0 offset:16384
    ds_read_b64_tr_b16 v[126:127], v0 offset:17408
    ds_read_b64_tr_b16 v[128:129], v5 offset:16384
    ds_read_b64_tr_b16 v[130:131], v5 offset:17408
    ds_read_b64_tr_b16 v[132:133], v7 offset:16384
    ds_read_b64_tr_b16 v[134:135], v7 offset:17408
    s_add_u32 s61, s60, 0x1000
    s_and_b32 s61, s61, 0x7000
    ds_read_b64_tr_b16 v[136:137], v6 offset:20480
    ds_read_b64_tr_b16 v[138:139], v6 offset:21504
    ds_read_b64_tr_b16 v[140:141], v0 offset:20480
    ds_read_b64_tr_b16 v[142:143], v0 offset:21504
    ds_read_b64_tr_b16 v[144:145], v5 offset:20480
    ds_read_b64_tr_b16 v[146:147], v5 offset:21504
    ds_read_b64_tr_b16 v[148:149], v7 offset:20480
    ds_read_b64_tr_b16 v[150:151], v7 offset:21504
    s_add_u32 s62, s61, 0x1000
    s_and_b32 s62, s62, 0x7000
    ds_read_b64_tr_b16 v[152:153], v6 offset:24576
    ds_read_b64_tr_b16 v[154:155], v6 offset:25600
    ds_read_b64_tr_b16 v[156:157], v0 offset:24576
    ds_read_b64_tr_b16 v[158:159], v0 offset:25600
    ds_read_b64_tr_b16 v[160:161], v5 offset:24576
    ds_read_b64_tr_b16 v[162:163], v5 offset:25600
    ds_read_b64_tr_b16 v[164:165], v7 offset:24576
    ds_read_b64_tr_b16 v[166:167], v7 offset:25600
    s_add_u32 s63, s62, 0x1000
    s_and_b32 s63, s63, 0x7000
    v_lshlrev_b32 v4, 4, v9
    v_mul_u32_u24 v12, 0x3000, v11
    v_lshl_add_u32 v4, v10, 9, v4
    v_lshlrev_b32 v2, 11, v9
    v_add3_u32 v4, v4, v12, s64
    v_lshl_add_u32 v2, v10, 5, v2
    v_lshl_add_u32 v2, v11, 4, v2
    s_branch L_lv_17
L_lw_16:
    s_sleep 1
L_lv_17:
    ds_read_b32 v24, v3 offset:96
    s_waitcnt lgkmcnt(0)
    v_readfirstlane_b32 s6, v24
    s_cmp_lt_u32 s6, 4
    s_cbranch_scc1 L_lw_16
    s_setprio 3
    ds_read_b128 v[24:27], v4
    buffer_load_dwordx4 v[28:31], v1, s[48:51], s57 offen sc1
    buffer_load_dwordx4 v[32:35], v1, s[48:51], s58 offen sc1
    buffer_load_dwordx4 v[36:39], v1, s[48:51], s59 offen sc1
    buffer_load_dwordx4 v[40:43], v1, s[48:51], s60 offen sc1
    buffer_load_dwordx4 v[44:47], v1, s[48:51], s61 offen sc1
    buffer_load_dwordx4 v[48:51], v1, s[48:51], s62 offen sc1
    buffer_load_dwordx4 v[52:55], v1, s[48:51], s63 offen sc1
    s_waitcnt lgkmcnt(0)
    v_mfma_f32_16x16x32_bf16 v[8:11], v[56:59], v[24:27], 0
    ds_read_b64_tr_b16 v[56:57], v6 offset:28672
    ds_read_b64_tr_b16 v[58:59], v6 offset:29696
    v_mfma_f32_16x16x32_bf16 v[12:15], v[60:63], v[24:27], 0
    ds_read_b64_tr_b16 v[60:61], v0 offset:28672
    ds_read_b64_tr_b16 v[62:63], v0 offset:29696
    v_mfma_f32_16x16x32_bf16 v[16:19], v[64:67], v[24:27], 0
    ds_read_b64_tr_b16 v[64:65], v5 offset:28672
    ds_read_b64_tr_b16 v[66:67], v5 offset:29696
    v_mfma_f32_16x16x32_bf16 v[20:23], v[68:71], v[24:27], 0
    ds_read_b64_tr_b16 v[68:69], v7 offset:28672
    ds_read_b64_tr_b16 v[70:71], v7 offset:29696
    s_waitcnt vmcnt(6)
    v_max3_u32 v24, v28, v29, v30
    v_max_u32 v24, v24, v31
    v_cmp_eq_u32 vcc, -1, v24
L_ob1:
    s_cbranch_vccnz L_or1
    v_mfma_f32_16x16x32_bf16 v[8:11], v[72:75], v[28:31], v[8:11]
    s_waitcnt vmcnt(5)
    v_max3_u32 v24, v32, v33, v34
    v_max_u32 v24, v24, v35
    v_cmp_eq_u32 vcc, -1, v24
    v_mfma_f32_16x16x32_bf16 v[12:15], v[76:79], v[28:31], v[12:15]
    v_mfma_f32_16x16x32_bf16 v[16:19], v[80:83], v[28:31], v[16:19]
    v_mfma_f32_16x16x32_bf16 v[20:23], v[84:87], v[28:31], v[20:23]
L_ob2:
    s_cbranch_vccnz L_or2
    v_mfma_f32_16x16x32_bf16 v[8:11], v[88:91], v[32:35], v[8:11]
    s_waitcnt vmcnt(4)
    v_max3_u32 v24, v36, v37, v38
    v_max_u32 v24, v24, v39
    v_cmp_eq_u32 vcc, -1, v24
    v_mfma_f32_16x16x32_bf16 v[12:15], v[92:95], v[32:35], v[12:15]
    v_mfma_f32_16x16x32_bf16 v[16:19], v[96:99], v[32:35], v[16:19]
    v_mfma_f32_16x16x32_bf16 v[20:23], v[100:103], v[32:35], v[20:23]
L_ob3:
    s_cbranch_vccnz L_or3
    v_mfma_f32_16x16x32_bf16 v[8:11], v[104:107], v[36:39], v[8:11]
    s_waitcnt vmcnt(3)
    v_max3_u32 v24, v40, v41, v42
    v_max_u32 v24, v24, v43
    v_cmp_eq_u32 vcc, -1, v24
    v_mfma_f32_16x16x32_bf16 v[12:15], v[108:111], v[36:39], v[12:15]
    v_mfma_f32_16x16x32_bf16 v[16:19], v[112:115], v[36:39], v[16:19]
    v_mfma_f32_16x16x32_bf16 v[20:23], v[116:119], v[36:39], v[20:23]
L_ob4:
    s_cbranch_vccnz L_or4
    v_mfma_f32_16x16x32_bf16 v[8:11], v[120:123], v[40:43], v[8:11]
    s_waitcnt vmcnt(2)
    v_max3_u32 v24, v44, v45, v46
    v_max_u32 v24, v24, v47
    v_cmp_eq_u32 vcc, -1, v24
    v_mfma_f32_16x16x32_bf16 v[12:15], v[124:127], v[40:43], v[12:15]
    v_mfma_f32_16x16x32_bf16 v[16:19], v[128:131], v[40:43], v[16:19]
    v_mfma_f32_16x16x32_bf16 v[20:23], v[132:135], v[40:43], v[20:23]
L_ob5:
    s_cbranch_vccnz L_or5
    v_mfma_f32_16x16x32_bf16 v[8:11], v[136:139], v[44:47], v[8:11]
    s_waitcnt vmcnt(1)
    v_max3_u32 v24, v48, v49, v50
    v_max_u32 v24, v24, v51
    v_cmp_eq_u32 vcc, -1, v24
    v_mfma_f32_16x16x32_bf16 v[12:15], v[140:143], v[44:47], v[12:15]
    v_mfma_f32_16x16x32_bf16 v[16:19], v[144:147], v[44:47], v[16:19]
    v_mfma_f32_16x16x32_bf16 v[20:23], v[148:151], v[44:47], v[20:23]
L_ob6:
    s_cbranch_vccnz L_or6
    v_mfma_f32_16x16x32_bf16 v[8:11], v[152:155], v[48:51], v[8:11]
    s_waitcnt vmcnt(0)
    v_max3_u32 v24, v52, v53, v54
    v_max_u32 v24, v24, v55
    v_cmp_eq_u32 vcc, -1, v24
    v_mfma_f32_16x16x32_bf16 v[12:15], v[156:159], v[48:51], v[12:15]
    v_mfma_f32_16x16x32_bf16 v[16:19], v[160:163], v[48:51], v[16:19]
    v_mfma_f32_16x16x32_bf16 v[20:23], v[164:167], v[48:51], v[20:23]
L_ob7:
    s_cbranch_vccnz L_or7
    ds_read_b32 v24, v3 offset:104
    s_waitcnt lgkmcnt(1)
    v_mfma_f32_16x16x32_bf16 v[8:11], v[56:59], v[52:55], v[8:11]
    v_add_u32 v1, 0x800, v1
    v_xor_b32 v4, 0x1000, v4
    s_lshl_b32 s7, s5, 7
    s_lshl2_add_u32 s56, s4, s54
    s_lshl_b32 s56, s56, 15
    s_add_u32 s56, s56, s7
    v_mfma_f32_16x16x32_bf16 v[12:15], v[60:63], v[52:55], v[12:15]
    v_mfma_f32_16x16x32_bf16 v[16:19], v[64:67], v[52:55], v[16:19]
    s_waitcnt lgkmcnt(0)
    v_readfirstlane_b32 s6, v24
    v_mfma_f32_16x16x32_bf16 v[20:23], v[68:71], v[52:55], v[20:23]
    s_cmp_lt_u32 s6, 4
    s_cbranch_scc1 L_orf
    buffer_load_dwordx4 v[28:31], v1, s[48:51], s57 offen sc1
    buffer_load_dwordx4 v[32:35], v1, s[48:51], s58 offen sc1
    buffer_load_dwordx4 v[36:39], v1, s[48:51], s59 offen sc1
    buffer_load_dwordx4 v[40:43], v1, s[48:51], s60 offen sc1
    buffer_load_dwordx4 v[44:47], v1, s[48:51], s61 offen sc1
    buffer_load_dwordx4 v[48:51], v1, s[48:51], s62 offen sc1
    buffer_load_dwordx4 v[52:55], v1, s[48:51], s63 offen sc1
    ds_read_b128 v[24:27], v4
L_orf:
    ds_read_b64_tr_b16 v[72:73], v6 offset:32768
    ds_read_b64_tr_b16 v[74:75], v6 offset:33792
    ds_read_b64_tr_b16 v[76:77], v0 offset:32768
    ds_read_b64_tr_b16 v[78:79], v0 offset:33792
    ds_read_b64_tr_b16 v[80:81], v5 offset:32768
    ds_read_b64_tr_b16 v[82:83], v5 offset:33792
    ds_read_b64_tr_b16 v[84:85], v7 offset:32768
    ds_read_b64_tr_b16 v[86:87], v7 offset:33792
    ds_read_b64_tr_b16 v[88:89], v6 offset:36864
    ds_read_b64_tr_b16 v[90:91], v6 offset:37888
    ds_read_b64_tr_b16 v[92:93], v0 offset:36864
    ds_read_b64_tr_b16 v[94:95], v0 offset:37888
    ds_read_b64_tr_b16 v[96:97], v5 offset:36864
    ds_read_b64_tr_b16 v[98:99], v5 offset:37888
    ds_read_b64_tr_b16 v[100:101], v7 offset:36864
    ds_read_b64_tr_b16 v[102:103], v7 offset:37888
    ds_read_b64_tr_b16 v[104:105], v6 offset:40960
    ds_read_b64_tr_b16 v[106:107], v6 offset:41984
    ds_read_b64_tr_b16 v[108:109], v0 offset:40960
    ds_read_b64_tr_b16 v[110:111], v0 offset:41984
    ds_read_b64_tr_b16 v[112:113], v5 offset:40960
    ds_read_b64_tr_b16 v[114:115], v5 offset:41984
    ds_read_b64_tr_b16 v[116:117], v7 offset:40960
    ds_read_b64_tr_b16 v[118:119], v7 offset:41984
    ds_read_b64_tr_b16 v[120:121], v6 offset:45056
    ds_read_b64_tr_b16 v[122:123], v6 offset:46080
    ds_read_b64_tr_b16 v[124:125], v0 offset:45056
    ds_read_b64_tr_b16 v[126:127], v0 offset:46080
    ds_read_b64_tr_b16 v[128:129], v5 offset:45056
    ds_read_b64_tr_b16 v[130:131], v5 offset:46080
    ds_read_b64_tr_b16 v[132:133], v7 offset:45056
    ds_read_b64_tr_b16 v[134:135], v7 offset:46080
    ds_read_b64_tr_b16 v[136:137], v6 offset:49152
    ds_read_b64_tr_b16 v[138:139], v6 offset:50176
    ds_read_b64_tr_b16 v[140:141], v0 offset:49152
    ds_read_b64_tr_b16 v[142:143], v0 offset:50176
    ds_read_b64_tr_b16 v[144:145], v5 offset:49152
    ds_read_b64_tr_b16 v[146:147], v5 offset:50176
    ds_read_b64_tr_b16 v[148:149], v7 offset:49152
    ds_read_b64_tr_b16 v[150:151], v7 offset:50176
    ds_read_b64_tr_b16 v[152:153], v6 offset:53248
    ds_read_b64_tr_b16 v[154:155], v6 offset:54272
    ds_read_b64_tr_b16 v[156:157], v0 offset:53248
    ds_read_b64_tr_b16 v[158:159], v0 offset:54272
    ds_read_b64_tr_b16 v[160:161], v5 offset:53248
    ds_read_b64_tr_b16 v[162:163], v5 offset:54272
    ds_read_b64_tr_b16 v[164:165], v7 offset:53248
    ds_read_b64_tr_b16 v[166:167], v7 offset:54272
    ds_read_b64_tr_b16 v[56:57], v6 offset:57344
    ds_read_b64_tr_b16 v[58:59], v6 offset:58368
    ds_read_b64_tr_b16 v[60:61], v0 offset:57344
    ds_read_b64_tr_b16 v[62:63], v0 offset:58368
    ds_read_b64_tr_b16 v[64:65], v5 offset:57344
    ds_read_b64_tr_b16 v[66:67], v5 offset:58368
    ds_read_b64_tr_b16 v[68:69], v7 offset:57344
    ds_read_b64_tr_b16 v[70:71], v7 offset:58368
    s_waitcnt lgkmcnt(15)
    s_cbranch_scc0 L_ogo
    s_branch L_lv_19
L_oh1:
    s_branch L_ohx
L_lw_18:
    s_sleep 1
L_lv_19:
    ds_read_b32 v24, v3 offset:104
    s_waitcnt lgkmcnt(0)
    v_readfirstlane_b32 s6, v24
    s_cmp_lt_u32 s6, 4
    s_cbranch_scc1 L_lw_18
    ds_read_b128 v[24:27], v4
    buffer_load_dwordx4 v[28:31], v1, s[48:51], s57 offen sc1
    buffer_load_dwordx4 v[32:35], v1, s[48:51], s58 offen sc1
    buffer_load_dwordx4 v[36:39], v1, s[48:51], s59 offen sc1
    buffer_load_dwordx4 v[40:43], v1, s[48:51], s60 offen sc1
    buffer_load_dwordx4 v[44:47], v1, s[48:51], s61 offen sc1
    buffer_load_dwordx4 v[48:51], v1, s[48:51], s62 offen sc1
    buffer_load_dwordx4 v[52:55], v1, s[48:51], s63 offen sc1
    s_waitcnt lgkmcnt(0)
L_ogo:
    v_mfma_f32_16x16x32_bf16 v[8:11], v[72:75], v[24:27], v[8:11]
    ds_read_b64_tr_b16 v[72:73], v6 offset:61440
    ds_read_b64_tr_b16 v[74:75], v6 offset:62464
    v_mfma_f32_16x16x32_bf16 v[12:15], v[76:79], v[24:27], v[12:15]
    ds_read_b64_tr_b16 v[76:77], v0 offset:61440
    ds_read_b64_tr_b16 v[78:79], v0 offset:62464
    v_mfma_f32_16x16x32_bf16 v[16:19], v[80:83], v[24:27], v[16:19]
    ds_read_b64_tr_b16 v[80:81], v5 offset:61440
    ds_read_b64_tr_b16 v[82:83], v5 offset:62464
    v_mfma_f32_16x16x32_bf16 v[20:23], v[84:87], v[24:27], v[20:23]
    ds_read_b64_tr_b16 v[84:85], v7 offset:61440
    ds_read_b64_tr_b16 v[86:87], v7 offset:62464
    s_waitcnt vmcnt(6)
    v_max3_u32 v24, v28, v29, v30
    v_max_u32 v24, v24, v31
    v_cmp_eq_u32 vcc, -1, v24
L_ob9:
    s_cbranch_vccnz L_or9
    v_mfma_f32_16x16x32_bf16 v[8:11], v[88:91], v[28:31], v[8:11]
    s_waitcnt vmcnt(5)
    v_max3_u32 v24, v32, v33, v34
    v_max_u32 v24, v24, v35
    v_cmp_eq_u32 vcc, -1, v24
    v_mfma_f32_16x16x32_bf16 v[12:15], v[92:95], v[28:31], v[12:15]
    v_mfma_f32_16x16x32_bf16 v[16:19], v[96:99], v[28:31], v[16:19]
    v_mfma_f32_16x16x32_bf16 v[20:23], v[100:103], v[28:31], v[20:23]
L_ob10:
    s_cbranch_vccnz L_or10
    v_mfma_f32_16x16x32_bf16 v[8:11], v[104:107], v[32:35], v[8:11]
    s_waitcnt vmcnt(4)
    v_max3_u32 v24, v36, v37, v38
    v_max_u32 v24, v24, v39
    v_cmp_eq_u32 vcc, -1, v24
    v_mfma_f32_16x16x32_bf16 v[12:15], v[108:111], v[32:35], v[12:15]
    v_mfma_f32_16x16x32_bf16 v[16:19], v[112:115], v[32:35], v[16:19]
    v_mfma_f32_16x16x32_bf16 v[20:23], v[116:119], v[32:35], v[20:23]
L_ob11:
    s_cbranch_vccnz L_or11
    v_mfma_f32_16x16x32_bf16 v[8:11], v[120:123], v[36:39], v[8:11]
    s_waitcnt vmcnt(3)
    v_max3_u32 v24, v40, v41, v42
    v_max_u32 v24, v24, v43
    v_cmp_eq_u32 vcc, -1, v24
    v_mfma_f32_16x16x32_bf16 v[12:15], v[124:127], v[36:39], v[12:15]
    v_mfma_f32_16x16x32_bf16 v[16:19], v[128:131], v[36:39], v[16:19]
    v_mfma_f32_16x16x32_bf16 v[20:23], v[132:135], v[36:39], v[20:23]
L_ob12:
    s_cbranch_vccnz L_or12
    s_waitcnt lgkmcnt(8)
    v_mfma_f32_16x16x32_bf16 v[8:11], v[136:139], v[40:43], v[8:11]
    s_waitcnt vmcnt(2)
    v_max3_u32 v24, v44, v45, v46
    v_max_u32 v24, v24, v47
    v_cmp_eq_u32 vcc, -1, v24
    v_mfma_f32_16x16x32_bf16 v[12:15], v[140:143], v[40:43], v[12:15]
    v_mfma_f32_16x16x32_bf16 v[16:19], v[144:147], v[40:43], v[16:19]
    v_mfma_f32_16x16x32_bf16 v[20:23], v[148:151], v[40:43], v[20:23]
L_ob13:
    s_cbranch_vccnz L_or13
    v_mfma_f32_16x16x32_bf16 v[8:11], v[152:155], v[44:47], v[8:11]
    s_waitcnt vmcnt(1)
    v_max3_u32 v24, v48, v49, v50
    v_max_u32 v24, v24, v51
    v_cmp_eq_u32 vcc, -1, v24
    v_mfma_f32_16x16x32_bf16 v[12:15], v[156:159], v[44:47], v[12:15]
    v_mfma_f32_16x16x32_bf16 v[16:19], v[160:163], v[44:47], v[16:19]
    v_mfma_f32_16x16x32_bf16 v[20:23], v[164:167], v[44:47], v[20:23]
L_ob14:
    s_cbranch_vccnz L_or14
    v_mfma_f32_16x16x32_bf16 v[8:11], v[56:59], v[48:51], v[8:11]
    s_waitcnt vmcnt(0)
    v_max3_u32 v24, v52, v53, v54
    v_max_u32 v24, v24, v55
    v_cmp_eq_u32 vcc, -1, v24
    v_mfma_f32_16x16x32_bf16 v[12:15], v[60:63], v[48:51], v[12:15]
    v_mfma_f32_16x16x32_bf16 v[16:19], v[64:67], v[48:51], v[16:19]
    v_mfma_f32_16x16x32_bf16 v[20:23], v[68:71], v[48:51], v[20:23]
L_ob15:
    s_cbranch_vccnz L_or15
    s_waitcnt lgkmcnt(0)
    v_mfma_f32_16x16x32_bf16 v[8:11], v[72:75], v[52:55], v[8:11]
    v_mfma_f32_16x16x32_bf16 v[12:15], v[76:79], v[52:55], v[12:15]
    v_mfma_f32_16x16x32_bf16 v[16:19], v[80:83], v[52:55], v[16:19]
    v_mfma_f32_16x16x32_bf16 v[20:23], v[84:87], v[52:55], v[20:23]
L_ofin:
    s_nop 4
    v_cvt_pk_bf16_f32 v28, v8, v9
    v_cvt_pk_bf16_f32 v29, v10, v11
    v_cvt_pk_bf16_f32 v30, v12, v13
    v_cvt_pk_bf16_f32 v31, v14, v15
    v_cvt_pk_bf16_f32 v32, v16, v17
    v_cvt_pk_bf16_f32 v33, v18, v19
    v_cvt_pk_bf16_f32 v34, v20, v21
    v_cvt_pk_bf16_f32 v35, v22, v23
    v_permlane16_swap_b32 v28, v30
    v_permlane16_swap_b32 v29, v31
    v_permlane16_swap_b32 v32, v34
    v_permlane16_swap_b32 v33, v35
    buffer_store_dwordx4 v[28:31], v2, s[44:47], s56 offen nt
    buffer_store_dwordx4 v[32:35], v2, s[44:47], s56 offen offset:64 nt
L_oend:
    s_endpgm
L_oh2:
    s_branch L_ohx
L_or9:
    buffer_load_dwordx4 v[28:31], v1, s[48:51], s57 offen sc1
    s_movk_i32 s67, 0xfe
    s_waitcnt vmcnt(1) lgkmcnt(0)
    s_branch L_gn1
L_or10:
    buffer_load_dwordx4 v[32:35], v1, s[48:51], s58 offen sc1
    s_movk_i32 s67, 0xfc
    s_waitcnt vmcnt(1) lgkmcnt(0)
    s_branch L_gn2
L_or11:
    buffer_load_dwordx4 v[36:39], v1, s[48:51], s59 offen sc1
    s_movk_i32 s67, 0xf8
    s_waitcnt vmcnt(1) lgkmcnt(0)
    s_branch L_gn3
L_or12:
    buffer_load_dwordx4 v[40:43], v1, s[48:51], s60 offen sc1
    s_movk_i32 s67, 0xf0
    s_waitcnt vmcnt(1) lgkmcnt(0)
    s_branch L_gn4
L_or13:
    buffer_load_dwordx4 v[44:47], v1, s[48:51], s61 offen sc1
    s_movk_i32 s67, 0xe0
    s_waitcnt vmcnt(1) lgkmcnt(0)
    s_branch L_gn5
L_or14:
    buffer_load_dwordx4 v[48:51], v1, s[48:51], s62 offen sc1
    s_movk_i32 s67, 0xc0
    s_waitcnt vmcnt(1) lgkmcnt(0)
    s_branch L_gn6
L_or15:
    buffer_load_dwordx4 v[52:55], v1, s[48:51], s63 offen sc1
    s_movk_i32 s67, 0x80
    s_waitcnt vmcnt(1) lgkmcnt(0)
    s_branch L_gn7
L_grd:
    s_waitcnt vmcnt(0)
    s_bitcmp1_b32 s67, 1
    s_cbranch_scc0 L_gn1
    v_max3_u32 v24, v28, v29, v30
    v_max_u32 v24, v24, v31
    v_cmp_eq_u32 vcc, -1, v24
    s_cbranch_vccnz L_gl1
    v_mfma_f32_16x16x32_bf16 v[8:11], v[88:91], v[28:31], v[8:11]
    v_mfma_f32_16x16x32_bf16 v[12:15], v[92:95], v[28:31], v[12:15]
    v_mfma_f32_16x16x32_bf16 v[16:19], v[96:99], v[28:31], v[16:19]
    v_mfma_f32_16x16x32_bf16 v[20:23], v[100:103], v[28:31], v[20:23]
    s_bitset0_b32 s67, 1
L_gn1:
    s_bitcmp1_b32 s67, 2
    s_cbranch_scc0 L_gn2
    v_max3_u32 v24, v32, v33, v34
    v_max_u32 v24, v24, v35
    v_cmp_eq_u32 vcc, -1, v24
    s_cbranch_vccnz L_gl2
    v_mfma_f32_16x16x32_bf16 v[8:11], v[104:107], v[32:35], v[8:11]
    v_mfma_f32_16x16x32_bf16 v[12:15], v[108:111], v[32:35], v[12:15]
    v_mfma_f32_16x16x32_bf16 v[16:19], v[112:115], v[32:35], v[16:19]
    v_mfma_f32_16x16x32_bf16 v[20:23], v[116:119], v[32:35], v[20:23]
    s_bitset0_b32 s67, 2
L_gn2:
    s_bitcmp1_b32 s67, 3
    s_cbranch_scc0 L_gn3
    v_max3_u32 v24, v36, v37, v38
    v_max_u32 v24, v24, v39
    v_cmp_eq_u32 vcc, -1, v24
    s_cbranch_vccnz L_gl3
    v_mfma_f32_16x16x32_bf16 v[8:11], v[120:123], v[36:39], v[8:11]
    v_mfma_f32_16x16x32_bf16 v[12:15], v[124:127], v[36:39], v[12:15]
    v_mfma_f32_16x16x32_bf16 v[16:19], v[128:131], v[36:39], v[16:19]
    v_mfma_f32_16x16x32_bf16 v[20:23], v[132:135], v[36:39], v[20:23]
    s_bitset0_b32 s67, 3
L_gn3:
    s_bitcmp1_b32 s67, 4
    s_cbranch_scc0 L_gn4
    v_max3_u32 v24, v40, v41, v42
    v_max_u32 v24, v24, v43
    v_cmp_eq_u32 vcc, -1, v24
    s_cbranch_vccnz L_gl4
    v_mfma_f32_16x16x32_bf16 v[8:11], v[136:139], v[40:43], v[8:11]
    v_mfma_f32_16x16x32_bf16 v[12:15], v[140:143], v[40:43], v[12:15]
    v_mfma_f32_16x16x32_bf16 v[16:19], v[144:147], v[40:43], v[16:19]
    v_mfma_f32_16x16x32_bf16 v[20:23], v[148:151], v[40:43], v[20:23]
    s_bitset0_b32 s67, 4
L_gn4:
    s_bitcmp1_b32 s67, 5
    s_cbranch_scc0 L_gn5
    v_max3_u32 v24, v44, v45, v46
    v_max_u32 v24, v24, v47
    v_cmp_eq_u32 vcc, -1, v24
    s_cbranch_vccnz L_gl5
    v_mfma_f32_16x16x32_bf16 v[8:11], v[152:155], v[44:47], v[8:11]
    v_mfma_f32_16x16x32_bf16 v[12:15], v[156:159], v[44:47], v[12:15]
    v_mfma_f32_16x16x32_bf16 v[16:19], v[160:163], v[44:47], v[16:19]
    v_mfma_f32_16x16x32_bf16 v[20:23], v[164:167], v[44:47], v[20:23]
    s_bitset0_b32 s67, 5
L_gn5:
    s_bitcmp1_b32 s67, 6
    s_cbranch_scc0 L_gn6
    v_max3_u32 v24, v48, v49, v50
    v_max_u32 v24, v24, v51
    v_cmp_eq_u32 vcc, -1, v24
    s_cbranch_vccnz L_gl6
    v_mfma_f32_16x16x32_bf16 v[8:11], v[56:59], v[48:51], v[8:11]
    v_mfma_f32_16x16x32_bf16 v[12:15], v[60:63], v[48:51], v[12:15]
    v_mfma_f32_16x16x32_bf16 v[16:19], v[64:67], v[48:51], v[16:19]
    v_mfma_f32_16x16x32_bf16 v[20:23], v[68:71], v[48:51], v[20:23]
    s_bitset0_b32 s67, 6
L_gn6:
    s_bitcmp1_b32 s67, 7
    s_cbranch_scc0 L_gn7
    v_max3_u32 v24, v52, v53, v54
    v_max_u32 v24, v24, v55
    v_cmp_eq_u32 vcc, -1, v24
    s_cbranch_vccnz L_gl7
    v_mfma_f32_16x16x32_bf16 v[8:11], v[72:75], v[52:55], v[8:11]
    v_mfma_f32_16x16x32_bf16 v[12:15], v[76:79], v[52:55], v[12:15]
    v_mfma_f32_16x16x32_bf16 v[16:19], v[80:83], v[52:55], v[16:19]
    v_mfma_f32_16x16x32_bf16 v[20:23], v[84:87], v[52:55], v[20:23]
    s_bitset0_b32 s67, 7
L_gn7:
    s_cmp_eq_u32 s67, 0
    s_cbranch_scc1 L_ofin
    s_sub_u32 s53, s53, 1
    s_cbranch_scc0 L_grd
    s_branch L_oend
L_gl1:
    buffer_load_dwordx4 v[28:31], v1, s[48:51], s57 offen sc1
    s_branch L_gn1
L_gl2:
    buffer_load_dwordx4 v[32:35], v1, s[48:51], s58 offen sc1
    s_branch L_gn2
L_gl3:
    buffer_load_dwordx4 v[36:39], v1, s[48:51], s59 offen sc1
    s_branch L_gn3
L_gl4:
    buffer_load_dwordx4 v[40:43], v1, s[48:51], s60 offen sc1
    s_branch L_gn4
L_gl5:
    buffer_load_dwordx4 v[44:47], v1, s[48:51], s61 offen sc1
    s_branch L_gn5
L_gl6:
    buffer_load_dwordx4 v[48:51], v1, s[48:51], s62 offen sc1
    s_branch L_gn6
L_gl7:
    buffer_load_dwordx4 v[52:55], v1, s[48:51], s63 offen sc1
    s_branch L_gn7
L_or1:
    s_mov_b32 s67, 1
    s_branch L_oq
L_or2:
    s_mov_b32 s67, 2
    s_branch L_oq
L_or3:
    s_mov_b32 s67, 3
    s_branch L_oq
L_or4:
    s_mov_b32 s67, 4
    s_branch L_oq
L_or5:
    s_mov_b32 s67, 5
    s_branch L_oq
L_or6:
    s_mov_b32 s67, 6
    s_branch L_oq
L_or7:
    s_mov_b32 s67, 7
L_oq:
    s_sub_u32 s53, s53, 1
    s_cbranch_scc1 L_oend
    s_waitcnt vmcnt(0)
    v_max3_u32 v24, v28, v29, v30
    v_max_u32 v24, v24, v31
    v_cmp_eq_u32 vcc, -1, v24
    s_cbranch_vccz L_oq1
    buffer_load_dwordx4 v[28:31], v1, s[48:51], s57 offen sc1
L_oq1:
    v_max3_u32 v24, v32, v33, v34
    v_max_u32 v24, v24, v35
    v_cmp_eq_u32 vcc, -1, v24
    s_cbranch_vccz L_oq2
    buffer_load_dwordx4 v[32:35], v1, s[48:51], s58 offen sc1
L_oq2:
    v_max3_u32 v24, v36, v37, v38
    v_max_u32 v24, v24, v39
    v_cmp_eq_u32 vcc, -1, v24
    s_cbranch_vccz L_oq3
    buffer_load_dwordx4 v[36:39], v1, s[48:51], s59 offen sc1
L_oq3:
    v_max3_u32 v24, v40, v41, v42
    v_max_u32 v24, v24, v43
    v_cmp_eq_u32 vcc, -1, v24
    s_cbranch_vccz L_oq4
    buffer_load_dwordx4 v[40:43], v1, s[48:51], s60 offen sc1
L_oq4:
    v_max3_u32 v24, v44, v45, v46
    v_max_u32 v24, v24, v47
    v_cmp_eq_u32 vcc, -1, v24
    s_cbranch_vccz L_oq5
    buffer_load_dwordx4 v[44:47], v1, s[48:51], s61 offen sc1
L_oq5:
    v_max3_u32 v24, v48, v49, v50
    v_max_u32 v24, v24, v51
    v_cmp_eq_u32 vcc, -1, v24
    s_cbranch_vccz L_oq6
    buffer_load_dwordx4 v[48:51], v1, s[48:51], s62 offen sc1
L_oq6:
    v_max3_u32 v24, v52, v53, v54
    v_max_u32 v24, v24, v55
    v_cmp_eq_u32 vcc, -1, v24
    s_cbranch_vccz L_oq7
    buffer_load_dwordx4 v[52:55], v1, s[48:51], s63 offen sc1
L_oq7:
    s_waitcnt vmcnt(0)
    s_cmp_lg_u32 s67, 1
    s_cbranch_scc1 L_oc1
    v_max3_u32 v24, v28, v29, v30
    v_max_u32 v24, v24, v31
    v_cmp_eq_u32 vcc, -1, v24
    s_branch L_ob1
L_oc1:
    s_cmp_lg_u32 s67, 2
    s_cbranch_scc1 L_oc2
    v_max3_u32 v24, v32, v33, v34
    v_max_u32 v24, v24, v35
    v_cmp_eq_u32 vcc, -1, v24
    s_branch L_ob2
L_oc2:
    s_cmp_lg_u32 s67, 3
    s_cbranch_scc1 L_oc3
    v_max3_u32 v24, v36, v37, v38
    v_max_u32 v24, v24, v39
    v_cmp_eq_u32 vcc, -1, v24
    s_branch L_ob3
L_oc3:
    s_cmp_lg_u32 s67, 4
    s_cbranch_scc1 L_oc4
    v_max3_u32 v24, v40, v41, v42
    v_max_u32 v24, v24, v43
    v_cmp_eq_u32 vcc, -1, v24
    s_branch L_ob4
L_oc4:
    s_cmp_lg_u32 s67, 5
    s_cbranch_scc1 L_oc5
    v_max3_u32 v24, v44, v45, v46
    v_max_u32 v24, v24, v47
    v_cmp_eq_u32 vcc, -1, v24
    s_branch L_ob5
L_oc5:
    s_cmp_lg_u32 s67, 6
    s_cbranch_scc1 L_oc6
    v_max3_u32 v24, v48, v49, v50
    v_max_u32 v24, v24, v51
    v_cmp_eq_u32 vcc, -1, v24
    s_branch L_ob6
L_oc6:
    v_max3_u32 v24, v52, v53, v54
    v_max_u32 v24, v24, v55
    v_cmp_eq_u32 vcc, -1, v24
    s_branch L_ob7
L_oc7:
L_oww:
    s_branch L_lv_21
L_lw_20:
    s_sleep 2
L_lv_21:
    ds_read_b32 v24, v3 offset:108
    s_waitcnt lgkmcnt(0)
    v_readfirstlane_b32 s6, v24
    s_cmp_lt_u32 s6, 4
    s_cbranch_scc1 L_lw_20
    s_branch L_owk
.p2align 12
L_hop1:
    s_branch L_g
L_aux2:
    v_and_b32 v16, 15, v0
    v_lshrrev_b32 v17, 4, v0
    v_xor_b32 v18, v16, v17
    v_lshlrev_b32 v18, 4, v18
    v_lshl_add_u32 v18, v16, 8, v18
    v_add_u32 v18, s58, v18
    v_xor_b32 v19, 64, v18
    v_xor_b32 v20, 0x80, v18
    v_xor_b32 v21, 0xc0, v18
    v_lshlrev_b32 v22, 8, v17
    v_lshl_add_u32 v22, v16, 3, v22
    v_add_u32 v22, s59, v22
    v_add_u32 v23, s59, v6
    v_lshrrev_b32 v24, s56, v17
    v_and_b32 v24, 1, v24
    s_xor_b32 s6, s56, 1
    v_lshrrev_b32 v25, s6, v17
    v_and_b32 v25, 1, v25
    v_lshlrev_b32 v24, 9, v24
    v_lshl_add_u32 v24, v25, 3, v24
    v_lshl_add_u32 v24, v16, 4, v24
    s_and_b32 s62, s4, 7
    s_lshl_b32 s62, s62, 2
    s_lshr_b32 s6, s4, 3
    s_add_u32 s62, s62, s6
    s_lshl_b32 s69, s62, 3
    s_add_u32 s69, s69, s5
    s_lshl_b32 s69, s69, 10
    s_add_u32 s69, s69, 0x80000
    s_lshl_b32 s62, s62, 12
    s_lshr_b32 s6, s55, 1
    s_lshl_b32 s6, s6, 11
    s_add_u32 s62, s62, s6
    s_lshl_b32 s6, s56, 10
    s_add_u32 s62, s62, s6
    s_and_b32 s6, s55, 1
    s_lshl_b32 s6, s6, 8
    s_add_u32 s62, s62, s6
    s_lshl_b32 s63, s4, 3
    s_add_u32 s63, s63, s5
    s_lshl_b32 s63, s63, 7
    s_add_u32 s15, s63, 0x48000
    s_lshl_b32 s57, s54, 13
    s_add_u32 s57, s57, 0x48000
    s_lshl_b32 s6, s4, 3
    v_add_u32 v8, s6, v0
    v_and_b32 v8, 63, v8
    v_lshlrev_b32 v8, 7, v8
    s_cmp_eq_u32 s56, 0
    s_cselect_b32 s70, 0x3eb8aa3b, 1.0
    s_mov_b32 s71, s70
    s_getreg_b32 s12, hwreg(HW_REG_XCC_ID, 0, 4)
    s_waitcnt vmcnt(0) lgkmcnt(0)
    s_add_u32 s52, s52, 1
    v_mov_b32 v126, s52
    v_mov_b32 v127, s12
    ds_read_b128 v[32:35], v18
    ds_read_b64_tr_b16 v[48:49], v22 offset:0
    ds_read_b64_tr_b16 v[50:51], v22 offset:128
    ds_read_b128 v[36:39], v19
    ds_read_b64_tr_b16 v[52:53], v22 offset:1024
    ds_read_b64_tr_b16 v[54:55], v22 offset:1152
    ds_read_b128 v[40:43], v20
    ds_read_b64_tr_b16 v[56:57], v22 offset:2048
    ds_read_b64_tr_b16 v[58:59], v22 offset:2176
    ds_read_b128 v[44:47], v21
    ds_read_b64_tr_b16 v[60:61], v22 offset:3072
    ds_read_b64_tr_b16 v[62:63], v22 offset:3200
    ds_add_u32 v3, v7 offset:136
    s_add_u32 s72, s69, 0x40000
    s_cmp_eq_u32 s56, 0
    s_cbranch_scc0 L_jobv
    s_waitcnt lgkmcnt(10)
    v_mfma_f32_16x16x32_bf16 v[120:123], v[48:51], v[32:35], 0
    s_waitcnt lgkmcnt(7)
    v_mfma_f32_16x16x32_bf16 v[120:123], v[52:55], v[36:39], v[120:123]
    s_waitcnt lgkmcnt(4)
    v_mfma_f32_16x16x32_bf16 v[120:123], v[56:59], v[40:43], v[120:123]
    s_waitcnt lgkmcnt(1)
    v_mfma_f32_16x16x32_bf16 v[120:123], v[60:63], v[44:47], v[120:123]
    s_branch L_jobd
L_jobv:
    s_waitcnt lgkmcnt(10)
    v_mfma_f32_16x16x32_bf16 v[120:123], v[32:35], v[48:51], 0
    s_waitcnt lgkmcnt(7)
    v_mfma_f32_16x16x32_bf16 v[120:123], v[36:39], v[52:55], v[120:123]
    s_waitcnt lgkmcnt(4)
    v_mfma_f32_16x16x32_bf16 v[120:123], v[40:43], v[56:59], v[120:123]
    s_waitcnt lgkmcnt(1)
    v_mfma_f32_16x16x32_bf16 v[120:123], v[44:47], v[60:63], v[120:123]
L_jobd:
    s_nop 7
    ds_write_b128 v23, v[120:123]
    ds_add_rtn_u32 v5, v3, v7 offset:44
    s_waitcnt lgkmcnt(0)
    v_readfirstlane_b32 s68, v5
    s_cmp_lg_u32 s68, 3
    s_cbranch_scc1 L_notlast
    ds_read_b128 v[32:35], v6 offset:0
    ds_read_b128 v[36:39], v6 offset:4096
    ds_read_b128 v[40:43], v6 offset:8192
    ds_read_b128 v[44:47], v6 offset:12288
    ds_add_u32 v3, v7 offset:44
    s_waitcnt lgkmcnt(1)
    v_pk_add_f32 v[32:33], v[32:33], v[36:37]
    v_pk_add_f32 v[40:41], v[40:41], v[44:45]
    v_pk_add_f32 v[34:35], v[34:35], v[38:39]
    v_pk_add_f32 v[42:43], v[42:43], v[46:47]
    v_pk_add_f32 v[32:33], v[32:33], v[40:41]
    v_pk_add_f32 v[34:35], v[34:35], v[42:43]
    v_pk_mul_f32 v[32:33], v[32:33], s[70:71]
    v_pk_mul_f32 v[34:35], v[34:35], s[70:71]
    v_cvt_pk_bf16_f32 v124, v32, v33
    v_cvt_pk_bf16_f32 v125, v34, v35
    buffer_store_dwordx4 v[124:127], v6, s[48:51], s72 offen
    buffer_store_dwordx2 v[124:125], v24, s[48:51], s62 offen sc1
    buffer_store_dwordx4 v[124:127], v6, s[48:51], s69 offen sc1
    ds_add_u32 v3, v7 offset:44
    s_waitcnt vmcnt(0)
    s_mov_b64 exec, 1
    buffer_store_dwordx2 v[126:127], off, s[48:51], s15 sc1
    s_mov_b64 exec, -1
L_notlast:
    s_and_b32 s61, s4, 7
    s_and_b32 s55, s4, 24
    s_add_u32 s55, s55, s5
    s_lshr_b32 s62, s54, 1
    s_and_b32 s63, s54, 1
    s_lshl_b32 s6, s61, 5
    s_add_u32 s6, s6, s55
    s_lshl_b32 s69, s6, 2
    s_load_dword s71, s[28:29], s69
    s_add_u32 s69, s69, s54
    s_lshl_b32 s69, s69, 11
    s_add_u32 s65, s69, 0x100000
    s_lshl_b32 s6, s6, 1
    s_add_u32 s6, s6, s62
    s_lshl_b32 s7, s6, 12
    s_add_u32 s32, s26, s7
    s_addc_u32 s33, s27, 0
    s_mov_b32 s34, 0x1000
    s_mov_b32 s35, 0x00020000
    s_load_dword s70, s[32:33], 0
    s_mov_b32 s36, s20
    s_mov_b32 s37, s21
    s_mov_b32 s38, 0x200000
    s_mov_b32 s39, 0x00020000
    s_mov_b32 s40, s22
    s_mov_b32 s41, s23
    s_mov_b32 s42, 0x200000
    s_mov_b32 s43, 0x00020000
    s_mov_b32 s44, s24
    s_mov_b32 s45, s25
    s_mov_b32 s46, 0x1000
    s_mov_b32 s47, 0x00020000
    v_mov_b32 v29, 16
    s_lshl_b32 s58, s61, 14
    s_add_u32 s58, s58, s59
    s_lshl_b32 s56, s4, 1
    s_add_u32 s56, s56, s63
    s_lshl_b32 s56, s56, 5
    s_lshl_b32 s7, s5, 2
    s_add_u32 s56, s56, s7
    s_and_b32 s7, s54, 2
    s_add_u32 s56, s56, s7
    s_lshl_b32 s56, s56, 10
    s_add_u32 s56, s56, 0x500000
    s_lshl_b32 s69, s61, 18
    s_add_u32 s69, s69, 0x100000
    s_lshl_b32 s6, s63, 6
    s_lshl_b32 s7, s55, 1
    s_add_u32 s7, s7, s62
    s_lshl_b32 s64, s6, 1
    s_add_u32 s64, s64, s7
    s_lshl_b32 s64, s64, 4
    s_add_u32 s64, s64, s69
    s_lshl_b32 s11, s61, 9
    s_add_u32 s11, s11, 0x42000
    s_lshl_b32 s6, s6, 2
    s_add_u32 s9, s11, s6
    s_lshl_b32 s7, s7, 2
    s_add_u32 s8, s9, s7
    s_add_u32 s10, s8, 0x1e000
    s_and_b32 s6, s55, 16
    s_lshl_b32 s6, s6, 4
    s_add_u32 s11, s11, s6
    s_add_u32 s11, s11, 0x1e000
    s_lshl_b32 s6, s55, 2
    s_add_u32 s6, s6, s54
    s_lshl_b32 s7, s6, 5
    s_add_u32 s69, s69, s7
    s_lshl_b32 s72, s6, 14
    s_lshl_b32 s7, s61, 7
    s_lshl_b32 s73, s72, 1
    s_add_u32 s72, s72, s7
    s_add_u32 s73, s73, s7
    s_add_u32 s73, s73, 0x400
    s_mul_i32 s74, s62, 8448
    s_add_u32 s74, s74, 131072
    s_mul_i32 s75, s54, 3072
    s_add_u32 s75, s75, 147968
    s_branch L_hop2x
L_hop2:
    s_branch L_g
L_hop2x:
    s_mul_i32 s60, s63, 4160
    s_add_u32 s60, s60, s74
    s_mov_b32 s66, s75
    v_and_b32 v32, 31, v0
    v_lshrrev_b32 v33, 5, v0
    v_lshrrev_b32 v34, 4, v0
    v_and_b32 v35, 15, v0
    v_lshrrev_b32 v36, 3, v0
    v_and_b32 v37, 7, v0
    v_lshrrev_b32 v38, 2, v0
    v_and_b32 v39, 4, v38
    v_xor_b32 v37, v37, v39
    v_lshlrev_b32 v10, 10, v36
    v_lshl_add_u32 v10, v37, 4, v10
    v_add_u32 v10, s72, v10
    v_subrev_u32 v11, 0x2000, v10
    v_add_u32 v12, 7168, v10
    v_lshlrev_b32 v13, 3, v0
    v_and_b32 v39, 2, v38
    v_xor_b32 v39, v39, v34
    v_and_b32 v40, 3, v38
    v_and_b32 v41, 3, v0
    v_lshlrev_b32 v14, 7, v40
    v_lshl_add_u32 v14, v39, 5, v14
    v_lshl_add_u32 v14, v41, 3, v14
    v_add_u32 v27, s66, v14
    v_add_u32 v14, s60, v14
    v_lshlrev_b32 v15, 2, v0
    v_and_b32 v42, 1, v0
    v_bfe_u32 v43, v0, 1, 1
    v_mul_u32_u24 v43, 1536, v43
    v_lshl_add_u32 v43, v38, 4, v43
    v_lshl_add_u32 v43, v42, 3, v43
    v_lshlrev_b32 v16, 7, v0
    v_add_u32 v21, s75, v43
    v_lshl_add_u32 v30, v34, 6, v21
    v_lshlrev_b32 v26, 12, v0
    v_lshlrev_b32 v28, 6, v32
    v_lshl_add_u32 v28, v33, 5, v28
    v_mul_u32_u24 v22, 1536, v33
    v_lshl_add_u32 v22, v32, 4, v22
    v_add_u32 v22, s75, v22
    v_add_u32 v20, 352, v22
    s_mul_i32 s6, s63, 4160
    s_add_u32 s6, s6, s74
    v_lshl_add_u32 v23, v0, 2, s6
    s_lshl_b32 s6, s63, 12
    s_add_u32 s7, s6, s74
    v_add_u32 v24, s7, v6
    s_xor_b32 s6, s6, 0x1000
    s_add_u32 s7, s6, s74
    v_add_u32 v25, s7, v6
    v_lshlrev_b32 v31, 4, v34
    v_lshl_add_u32 v2, v35, 11, v31
    v_lshl_add_u32 v31, v35, 10, v31
    v_bfe_u32 v40, v0, 1, 2
    v_xor_b32 v40, v40, v34
    v_lshlrev_b32 v1, 10, v36
    v_lshl_add_u32 v1, v42, 4, v1
    v_lshl_add_u32 v1, v40, 5, v1
    s_lshl_b32 s6, s62, 2
    v_add_u32 v4, s6, v3
    v_and_b32 v40, 3, v0
    v_bfe_u32 v41, v0, 3, 2
    v_lshl_add_u32 v40, v41, 2, v40
    v_bfe_u32 v41, v0, 2, 1
    v_lshl_add_u32 v40, v41, 4, v40
    s_lshl_b32 s6, s63, 4
    s_add_u32 s6, s6, 7
    v_lshl_add_u32 v41, v33, 3, s6
    v_sub_u32 v40, v40, v41
    v_and_b32 v41, 1, v40
    v_mul_u32_u24 v18, 4162, v41
    v_lshl_add_u32 v18, v40, 1, v18
    s_add_u32 s6, s74, 64
    v_add_u32 v18, s6, v18
    v_add_u32 v19, 0x800, v18
    v_sub_u32 v40, 0, v40
    v_lshrrev_b32 v40, 1, v40
    v_lshlrev_b32 v41, 4, v41
    v_mov_b32 v144, -1
    v_mov_b32 v148, 0
    v_mov_b32 v145, -1
    v_mov_b32 v149, 0
    v_mov_b32 v146, -1
    v_mov_b32 v150, 0
    v_mov_b32 v147, -1
    v_mov_b32 v151, 0
    s_waitcnt lgkmcnt(0)
    s_lshl_b32 s6, s62, 4
    s_lshr_b32 s71, s71, s6
    s_and_b32 s71, s71, 0xffff
    s_lshl_b32 s70, s70, 16
    v_lshlrev_b32 v41, v41, s71
    v_mov_b32 v152, s70
    v_cmp_eq_u32 vcc, 16, v0
    s_lshl_b32 s61, s61, 9
    s_nop 0
    v_cndmask_b32 v152, 0, v152, vcc
    v_cmp_eq_u32 vcc, 0, v40
    s_nop 1
    v_cndmask_b32 v160, 0, v41, vcc
    v_cmp_eq_u32 vcc, 1, v40
    s_nop 1
    v_cndmask_b32 v161, 0, v41, vcc
    v_cmp_eq_u32 vcc, 2, v40
    s_nop 1
    v_cndmask_b32 v162, 0, v41, vcc
    v_cmp_eq_u32 vcc, 3, v40
    s_nop 1
    v_cndmask_b32 v163, 0, v41, vcc
    s_add_u32 s20, s4, 1
    s_and_b32 s20, s20, 7
    s_lshl2_add_u32 s20, s20, s54
    s_lshl_b32 s20, s20, 13
    s_add_u32 s20, s20, 0x80000
    s_add_u32 s21, s20, 0x1000
    s_add_u32 s6, s59, 0x4000
    v_lshl_add_u32 v45, v35, 4, s6
    v_and_b32 v46, 1, v34
    v_lshrrev_b32 v47, 1, v34
    v_lshl_add_u32 v44, v46, 9, v45
    v_lshl_add_u32 v44, v47, 3, v44
    v_lshl_add_u32 v45, v47, 9, v45
    v_lshl_add_u32 v45, v46, 3, v45
L_lw_22:
    ds_read_b32 v5, v3 offset:156
    s_waitcnt lgkmcnt(0)
    v_readfirstlane_b32 s6, v5
    s_cmp_lt_u32 s6, 4
    s_cbranch_scc1 L_lw_22
    buffer_load_dwordx4 v[64:67], v6, s[48:51], s20 offen sc1
    buffer_load_dwordx4 v[68:71], v6, s[48:51], s20 offen offset:1024 sc1
    buffer_load_dwordx4 v[72:75], v6, s[48:51], s20 offen offset:2048 sc1
    buffer_load_dwordx4 v[76:79], v6, s[48:51], s20 offen offset:3072 sc1
    buffer_load_dwordx4 v[80:83], v6, s[48:51], s21 offen sc1
    buffer_load_dwordx4 v[84:87], v6, s[48:51], s21 offen offset:1024 sc1
    buffer_load_dwordx4 v[88:91], v6, s[48:51], s21 offen offset:2048 sc1
    buffer_load_dwordx4 v[92:95], v6, s[48:51], s21 offen offset:3072 sc1
    s_mov_b64 exec, 0xff0000
    buffer_load_dword v9, v8, s[48:51], s57 offen sc1
    s_mov_b64 exec, -1
L_lw_23:
    ds_read_b32 v5, v3 offset:140
    s_waitcnt lgkmcnt(0)
    v_readfirstlane_b32 s6, v5
    s_cmp_lt_u32 s6, 4
    s_cbranch_scc1 L_lw_23
L_t2c:
    s_mov_b64 s[22:23], 0
    s_waitcnt vmcnt(8)
    ds_write_b64 v44, v[64:65] offset:0
    v_cmp_ne_u32 vcc, s52, v66
    s_or_b64 s[22:23], s[22:23], vcc
    s_waitcnt vmcnt(7)
    ds_write_b64 v45, v[68:69] offset:1024
    v_cmp_ne_u32 vcc, s52, v70
    s_or_b64 s[22:23], s[22:23], vcc
    s_waitcnt vmcnt(6)
    ds_write_b64 v44, v[72:73] offset:256
    v_cmp_ne_u32 vcc, s52, v74
    s_or_b64 s[22:23], s[22:23], vcc
    s_waitcnt vmcnt(5)
    ds_write_b64 v45, v[76:77] offset:1280
    v_cmp_ne_u32 vcc, s52, v78
    s_or_b64 s[22:23], s[22:23], vcc
    s_waitcnt vmcnt(4)
    ds_write_b64 v44, v[80:81] offset:2048
    v_cmp_ne_u32 vcc, s52, v82
    s_or_b64 s[22:23], s[22:23], vcc
    s_waitcnt vmcnt(3)
    ds_write_b64 v45, v[84:85] offset:3072
    v_cmp_ne_u32 vcc, s52, v86
    s_or_b64 s[22:23], s[22:23], vcc
    s_waitcnt vmcnt(2)
    ds_write_b64 v44, v[88:89] offset:2304
    v_cmp_ne_u32 vcc, s52, v90
    s_or_b64 s[22:23], s[22:23], vcc
    s_waitcnt vmcnt(1)
    ds_write_b64 v45, v[92:93] offset:3328
    v_cmp_ne_u32 vcc, s52, v94
    s_or_b64 s[22:23], s[22:23], vcc
    s_cbranch_scc0 L_t2k
L_t2r:
    s_sub_u32 s53, s53, 1
    s_cbranch_scc0 L_t2r0
    s_mov_b32 s53, 0
    s_branch L_t2k
L_t2r0:
    s_waitcnt lgkmcnt(0)
    s_sleep 2
    v_cmp_ne_u32 vcc, s52, v66
    s_cbranch_vccz L_t2r1
    buffer_load_dwordx4 v[64:67], v6, s[48:51], s20 offen sc1
L_t2r1:
    v_cmp_ne_u32 vcc, s52, v70
    s_cbranch_vccz L_t2r2
    buffer_load_dwordx4 v[68:71], v6, s[48:51], s20 offen offset:1024 sc1
L_t2r2:
    v_cmp_ne_u32 vcc, s52, v74
    s_cbranch_vccz L_t2r3
    buffer_load_dwordx4 v[72:75], v6, s[48:51], s20 offen offset:2048 sc1
L_t2r3:
    v_cmp_ne_u32 vcc, s52, v78
    s_cbranch_vccz L_t2r4
    buffer_load_dwordx4 v[76:79], v6, s[48:51], s20 offen offset:3072 sc1
L_t2r4:
    v_cmp_ne_u32 vcc, s52, v82
    s_cbranch_vccz L_t2r5
    buffer_load_dwordx4 v[80:83], v6, s[48:51], s21 offen sc1
L_t2r5:
    v_cmp_ne_u32 vcc, s52, v86
    s_cbranch_vccz L_t2r6
    buffer_load_dwordx4 v[84:87], v6, s[48:51], s21 offen offset:1024 sc1
L_t2r6:
    v_cmp_ne_u32 vcc, s52, v90
    s_cbranch_vccz L_t2r7
    buffer_load_dwordx4 v[88:91], v6, s[48:51], s21 offen offset:2048 sc1
L_t2r7:
    v_cmp_ne_u32 vcc, s52, v94
    s_cbranch_vccz L_t2r8
    buffer_load_dwordx4 v[92:95], v6, s[48:51], s21 offen offset:3072 sc1
L_t2r8:
    s_waitcnt vmcnt(0)
    s_branch L_t2c
L_t2k:
    ds_add_u32 v3, v29 offset:0
    s_mov_b64 exec, 0xff0000
    s_branch L_gpw_25
L_gp_24:
    buffer_load_dword v9, v8, s[48:51], s57 offen sc1
L_gpw_25:
    s_waitcnt vmcnt(0)
    v_cmp_ne_u32 vcc, s52, v9
    s_cbranch_vccz L_gpd_26
    s_mov_b64 exec, vcc
    s_sleep 2
    s_sub_u32 s53, s53, 1
    s_cbranch_scc0 L_gp_24
    s_mov_b32 s53, 0
L_gpd_26:
    s_mov_b64 exec, -1
    s_add_u32 m0, s59, 0x8000
    s_add_u32 s6, s58, 0x8000
    s_and_b32 s6, s6, 0x1ffff
    buffer_load_dwordx4 v6, s[48:51], s6 offen sc1 lds
    buffer_load_dwordx4 v6, s[48:51], s6 offen offset:1024 sc1 lds
    buffer_load_dwordx4 v6, s[48:51], s6 offen offset:2048 sc1 lds
    buffer_load_dwordx4 v6, s[48:51], s6 offen offset:3072 sc1 lds
    buffer_load_dwordx2 v[154:155], v8, s[48:51], s57 offen sc1
    s_waitcnt vmcnt(1)
    ds_add_u32 v3, v29 offset:4
    s_branch L_gpw_28
L_gp_27:
    buffer_load_dwordx2 v[154:155], v8, s[48:51], s57 offen sc1
L_gpw_28:
    s_waitcnt vmcnt(0)
    v_cmp_ne_u32 vcc, s52, v154
    s_cbranch_vccz L_gpd_29
    s_mov_b64 exec, vcc
    s_sleep 2
    s_sub_u32 s53, s53, 1
    s_cbranch_scc0 L_gp_27
    s_mov_b32 s53, 0
L_gpd_29:
    s_mov_b64 exec, -1
    s_mov_b64 exec, 0xff
    v_cmp_ne_u32 vcc, s12, v155
    s_mov_b64 exec, -1
    s_cmp_eq_u64 vcc, 0
    s_cselect_b32 s6, 1, 0x101
    v_mov_b32 v9, s6
    ds_add_u32 v3, v9 offset:80
    s_add_u32 m0, s59, 0xc000
    s_add_u32 s6, s58, 0xc000
    s_and_b32 s6, s6, 0x1ffff
    buffer_load_dwordx4 v6, s[48:51], s6 offen sc1 lds
    buffer_load_dwordx4 v6, s[48:51], s6 offen offset:1024 sc1 lds
    buffer_load_dwordx4 v6, s[48:51], s6 offen offset:2048 sc1 lds
    buffer_load_dwordx4 v6, s[48:51], s6 offen offset:3072 sc1 lds
L_lw_30:
    ds_read_b32 v5, v3 offset:152
    s_waitcnt lgkmcnt(0)
    v_readfirstlane_b32 s6, v5
    s_cmp_lt_u32 s6, 4
    s_cbranch_scc1 L_lw_30
    s_add_u32 m0, s59, 0x10000
    s_add_u32 s6, s58, 0x10000
    s_and_b32 s6, s6, 0x1ffff
    buffer_load_dwordx4 v6, s[48:51], s6 offen sc1 lds
    buffer_load_dwordx4 v6, s[48:51], s6 offen offset:1024 sc1 lds
    buffer_load_dwordx4 v6, s[48:51], s6 offen offset:2048 sc1 lds
    buffer_load_dwordx4 v6, s[48:51], s6 offen offset:3072 sc1 lds
    s_add_u32 m0, s59, 0x14000
    s_add_u32 s6, s58, 0x14000
    s_and_b32 s6, s6, 0x1ffff
    buffer_load_dwordx4 v6, s[48:51], s6 offen sc1 lds
    buffer_load_dwordx4 v6, s[48:51], s6 offen offset:1024 sc1 lds
    buffer_load_dwordx4 v6, s[48:51], s6 offen offset:2048 sc1 lds
    buffer_load_dwordx4 v6, s[48:51], s6 offen offset:3072 sc1 lds
    s_add_u32 m0, s59, 0x18000
    s_add_u32 s6, s58, 0x18000
    s_and_b32 s6, s6, 0x1ffff
    buffer_load_dwordx4 v6, s[48:51], s6 offen sc1 lds
    buffer_load_dwordx4 v6, s[48:51], s6 offen offset:1024 sc1 lds
    buffer_load_dwordx4 v6, s[48:51], s6 offen offset:2048 sc1 lds
    buffer_load_dwordx4 v6, s[48:51], s6 offen offset:3072 sc1 lds
L_lw_31:
    ds_read_b32 v5, v3 offset:52
    s_waitcnt lgkmcnt(0)
    v_readfirstlane_b32 s6, v5
    s_cmp_lt_u32 s6, 4
    s_cbranch_scc1 L_lw_31
    s_add_u32 m0, s59, 0x1c000
    s_add_u32 s6, s58, 0x1c000
    s_and_b32 s6, s6, 0x1ffff
    buffer_load_dwordx4 v6, s[48:51], s6 offen sc1 lds
    buffer_load_dwordx4 v6, s[48:51], s6 offen offset:1024 sc1 lds
    buffer_load_dwordx4 v6, s[48:51], s6 offen offset:2048 sc1 lds
    buffer_load_dwordx4 v6, s[48:51], s6 offen offset:3072 sc1 lds
    s_mov_b32 m0, s60
    buffer_load_dwordx2 v[124:125], v13, s[44:47], s61 offen
    buffer_load_dwordx4 v11, s[36:39], 0 offen lds
    s_add_u32 m0, s60, 1024
    s_nop 0
    buffer_load_dwordx4 v10, s[36:39], 0 offen lds
    buffer_load_dwordx4 v12, s[36:39], 0 offen offset:1024 lds
    s_mov_b32 m0, s66
    s_nop 0
    buffer_load_dwordx4 v10, s[40:43], 0 offen lds
    buffer_load_dwordx4 v12, s[40:43], 0 offen offset:1024 lds
    s_mov_b64 exec, 0xffff
    buffer_load_dword v153, v16, s[48:51], s65 offen sc1
    s_mov_b64 exec, 3
    buffer_load_dword v153, v16, s[48:51], s9 offen sc1
    buffer_load_dword v153, v16, s[48:51], s11 offen sc1
    s_mov_b64 exec, -1
    s_waitcnt vmcnt(25)
    ds_add_u32 v3, v29 offset:8
    s_waitcnt vmcnt(21)
    ds_add_u32 v3, v29 offset:12
    s_waitcnt vmcnt(17)
    ds_add_u32 v3, v29 offset:16
    s_waitcnt vmcnt(13)
    ds_add_u32 v3, v29 offset:20
    s_waitcnt vmcnt(9)
    ds_add_u32 v3, v29 offset:24
    s_waitcnt vmcnt(3)
    ds_read_b64_tr_b16 v[96:97], v14 offset:512
    ds_read_b64_tr_b16 v[98:99], v14 offset:1024
    ds_read_b64_tr_b16 v[100:101], v14 offset:1536
    ds_read_b64_tr_b16 v[102:103], v14 offset:2048
    ds_read_b64_tr_b16 v[104:105], v14 offset:2560
    ds_read_b64_tr_b16 v[106:107], v27 offset:0
    ds_read_b64_tr_b16 v[108:109], v27 offset:512
    ds_read_b64_tr_b16 v[110:111], v27 offset:1024
    ds_read_b64_tr_b16 v[112:113], v27 offset:1536
    v_alignbit_b32 v124, v124, v124, 16
    v_alignbit_b32 v125, v125, v125, 16
    s_waitcnt lgkmcnt(4)
    v_dot2_f32_bf16 v33, v98, v124, 0
    v_dot2_f32_bf16 v35, v99, v124, 0
    v_dot2_f32_bf16 v37, v100, v124, 0
    v_dot2_f32_bf16 v39, v101, v124, 0
    v_dot2_f32_bf16 v41, v102, v124, 0
    v_dot2_f32_bf16 v43, v103, v124, 0
    v_dot2_f32_bf16 v45, v104, v124, 0
    v_dot2_f32_bf16 v47, v105, v124, 0
    v_alignbit_b32 v114, v97, v96, 16
    v_alignbit_b32 v115, v98, v97, 16
    v_alignbit_b32 v116, v99, v98, 16
    v_alignbit_b32 v117, v100, v99, 16
    v_alignbit_b32 v118, v101, v100, 16
    v_alignbit_b32 v119, v102, v101, 16
    v_alignbit_b32 v120, v103, v102, 16
    v_alignbit_b32 v121, v104, v103, 16
    v_alignbit_b32 v122, v105, v104, 16
    v_dot2_f32_bf16 v32, v115, v124, 0
    v_dot2_f32_bf16 v34, v116, v124, 0
    v_dot2_f32_bf16 v36, v117, v124, 0
    v_dot2_f32_bf16 v38, v118, v124, 0
    v_dot2_f32_bf16 v40, v119, v124, 0
    v_dot2_f32_bf16 v42, v120, v124, 0
    v_dot2_f32_bf16 v44, v121, v124, 0
    v_dot2_f32_bf16 v46, v122, v124, 0
    v_dot2_f32_bf16 v33, v97, v125, v33
    v_dot2_f32_bf16 v35, v98, v125, v35
    v_dot2_f32_bf16 v37, v99, v125, v37
    v_dot2_f32_bf16 v39, v100, v125, v39
    v_dot2_f32_bf16 v41, v101, v125, v41
    v_dot2_f32_bf16 v43, v102, v125, v43
    v_dot2_f32_bf16 v45, v103, v125, v45
    v_dot2_f32_bf16 v47, v104, v125, v47
    v_dot2_f32_bf16 v32, v114, v125, v32
    v_dot2_f32_bf16 v34, v115, v125, v34
    v_dot2_f32_bf16 v36, v116, v125, v36
    v_dot2_f32_bf16 v38, v117, v125, v38
    v_dot2_f32_bf16 v40, v118, v125, v40
    v_dot2_f32_bf16 v42, v119, v125, v42
    v_dot2_f32_bf16 v44, v120, v125, v44
    v_dot2_f32_bf16 v46, v121, v125, v46
    s_waitcnt lgkmcnt(0)
    v_lshlrev_b32 v48, 16, v106
    v_and_b32 v49, 0xffff0000, v106
    v_lshlrev_b32 v50, 16, v107
    v_and_b32 v51, 0xffff0000, v107
    v_lshlrev_b32 v52, 16, v108
    v_and_b32 v53, 0xffff0000, v108
    v_lshlrev_b32 v54, 16, v109
    v_and_b32 v55, 0xffff0000, v109
    v_lshlrev_b32 v56, 16, v110
    v_and_b32 v57, 0xffff0000, v110
    v_lshlrev_b32 v58, 16, v111
    v_and_b32 v59, 0xffff0000, v111
    v_lshlrev_b32 v60, 16, v112
    v_and_b32 v61, 0xffff0000, v112
    v_lshlrev_b32 v62, 16, v113
    v_and_b32 v63, 0xffff0000, v113
    v_pk_mul_f32 v[32:33], v[32:33], v[48:49]
    v_pk_mul_f32 v[34:35], v[34:35], v[50:51]
    v_pk_mul_f32 v[36:37], v[36:37], v[52:53]
    v_pk_mul_f32 v[38:39], v[38:39], v[54:55]
    v_pk_mul_f32 v[40:41], v[40:41], v[56:57]
    v_pk_mul_f32 v[42:43], v[42:43], v[58:59]
    v_pk_mul_f32 v[44:45], v[44:45], v[60:61]
    v_pk_mul_f32 v[46:47], v[46:47], v[62:63]
    v_cvt_pk_bf16_f32 v128, v39, v38
    v_cvt_pk_bf16_f32 v129, v37, v36
    v_cvt_pk_bf16_f32 v130, v35, v34
    v_cvt_pk_bf16_f32 v131, v33, v32
    v_cvt_pk_bf16_f32 v132, v47, v46
    v_cvt_pk_bf16_f32 v133, v45, v44
    v_cvt_pk_bf16_f32 v134, v43, v42
    v_cvt_pk_bf16_f32 v135, v41, v40
L_bm:
    ds_read_b32 v5, v3 offset:80
    s_waitcnt lgkmcnt(0)
    v_readfirstlane_b32 s13, v5
    s_and_b32 s6, s13, 0xff
    s_cmp_lt_u32 s6, 4
    s_cbranch_scc1 L_bm
    s_cmp_gt_u32 s13, 4
    s_cbranch_scc1 L_ks1
    buffer_store_dwordx4 v[128:131], v26, s[48:51], s64 offen offset:0
    buffer_store_dwordx4 v[132:135], v26, s[48:51], s64 offen offset:1024
L_ks2:
    s_mul_i32 s6, s63, 4164
    s_add_u32 s6, s6, s74
    s_add_u32 m0, s6, 64
    s_lshl_b32 s7, s63, 1
    buffer_load_dwordx4 v6, s[32:35], s7 offen lds
    buffer_load_dwordx4 v6, s[32:35], s7 offen offset:1024 lds
    buffer_load_dwordx4 v6, s[32:35], s7 offen offset:2048 lds
    buffer_load_dwordx4 v6, s[32:35], s7 offen offset:3072 lds
    ds_write_b128 v22, v[148:151]
    s_lshl_b32 s6, 0x10000, s63
    s_sub_u32 exec_lo, s6, 1
    s_mov_b32 exec_hi, 0
    ds_write_b32 v23, v152
    s_mov_b64 exec, -1
    s_waitcnt vmcnt(4)
    v_mov_b32 v5, s52
    s_mov_b64 exec, 1
    s_cmp_gt_u32 s13, 4
    s_cbranch_scc1 L_kf1
    buffer_store_dword v5, off, s[48:51], s8
L_kf2:
    s_mov_b64 exec, -1
    s_mov_b32 s40, s18
    s_mov_b32 s41, s19
    s_mov_b32 s42, 0x200000
    s_mov_b32 s43, 0x00020000
    s_mov_b32 s44, s30
    s_mov_b32 s45, s31
    s_mov_b32 s46, 0x400000
    s_mov_b32 s47, 0x00020000
    s_mov_b32 s36, s16
    s_mov_b32 s37, s17
    s_mov_b32 s38, 0x80000
    s_mov_b32 s39, 0x00020000
    s_cmp_eq_u32 s54, 0
    s_cbranch_scc1 L_oh0
    s_cmp_eq_u32 s54, 1
    s_cbranch_scc1 L_oh1
    s_cmp_eq_u32 s54, 2
    s_cbranch_scc1 L_oh2
    s_branch L_oh3
L_ohx:
L_gp_32:
    buffer_load_dword v9, v15, s[48:51], s9 offen sc1
L_gpw_33:
    s_waitcnt vmcnt(0)
    v_cmp_ne_u32 vcc, s52, v9
    s_cbranch_vccz L_gpd_34
    s_mov_b64 exec, vcc
    s_sleep 4
    s_sub_u32 s53, s53, 1
    s_cbranch_scc0 L_gp_32
    s_mov_b32 s53, 0
L_gpd_34:
    s_mov_b64 exec, -1
    s_add_u32 m0, s75, 512
    s_nop 0
    buffer_load_dwordx4 v6, s[48:51], s65 offen sc1 lds
    s_add_u32 m0, s75, 1024
    s_nop 0
    buffer_load_dwordx4 v6, s[48:51], s65 offen offset:1024 sc1 lds
    ds_add_u32 v4, v7 offset:84
    buffer_store_dwordx4 v[144:147], v6, s[48:51], s56 offen sc1
    buffer_store_dwordx4 v[144:147], v6, s[48:51], s56 offen offset:1024 sc1
    buffer_load_dwordx4 v[8:11], v31, s[40:43], s72 offen
    buffer_load_dwordx4 v[12:15], v31, s[40:43], s72 offen offset:64
    v_lshlrev_b32 v16, 10, v0
    s_lshr_b32 s6, s4, 3
    s_lshl_b32 s6, s6, 2
    s_add_u32 s6, s6, s54
    s_lshl_b32 s6, s6, 15
    s_lshl_b32 s7, s5, 7
    s_add_u32 s6, s6, s7
    s_mov_b32 exec_hi, 0
    buffer_load_dword v165, v16, s[36:39], s6 offen
    s_mov_b64 exec, -1
L_lw_35:
    ds_read_b32 v5, v4 offset:84
    s_waitcnt lgkmcnt(0)
    v_readfirstlane_b32 s6, v5
    s_cmp_lt_u32 s6, 2
    s_cbranch_scc1 L_lw_35
    s_waitcnt vmcnt(5)
    s_setprio 3
    ds_read_b128 v[104:107], v20 offset:160
    ds_read2_b32 v[96:97], v18 offset0:0 offset1:1
    ds_read2_b32 v[98:99], v18 offset0:2 offset1:3
    ds_read_b128 v[108:111], v20 offset:672
    ds_read2_b32 v[100:101], v19 offset0:0 offset1:1
    ds_read2_b32 v[102:103], v19 offset0:2 offset1:3
    s_mov_b32 s66, 4
    s_waitcnt lgkmcnt(2)
    v_mfma_f32_32x32x16_bf16 v[32:47], v[160:163], v[104:107], 0
    v_mfma_f32_32x32x16_bf16 v[48:63], v[160:163], v[108:111], 0
L_conv:
    s_waitcnt lgkmcnt(0)
    v_mfma_f32_32x32x16_bf16 v[32:47], v[96:99], v[104:107], v[32:47]
    v_mfma_f32_32x32x16_bf16 v[48:63], v[96:99], v[108:111], v[48:63]
    v_mfma_f32_32x32x16_bf16 v[48:63], v[100:103], v[104:107], v[48:63]
    ds_read_b128 v[120:123], v20 offset:144
    ds_read2_b32 v[112:113], v18 offset0:16 offset1:17
    ds_read2_b32 v[114:115], v18 offset0:18 offset1:19
    ds_read_b128 v[124:127], v20 offset:656
    ds_read2_b32 v[116:117], v19 offset0:16 offset1:17
    ds_read2_b32 v[118:119], v19 offset0:18 offset1:19
    s_waitcnt lgkmcnt(0)
    v_mfma_f32_32x32x16_bf16 v[32:47], v[112:115], v[120:123], v[32:47]
    v_mfma_f32_32x32x16_bf16 v[48:63], v[112:115], v[124:127], v[48:63]
    v_mfma_f32_32x32x16_bf16 v[48:63], v[116:119], v[120:123], v[48:63]
    ds_read_b128 v[136:139], v20 offset:128
    ds_read2_b32 v[128:129], v18 offset0:32 offset1:33
    ds_read2_b32 v[130:131], v18 offset0:34 offset1:35
    ds_read_b128 v[140:143], v20 offset:640
    ds_read2_b32 v[132:133], v19 offset0:32 offset1:33
    ds_read2_b32 v[134:135], v19 offset0:34 offset1:35
    s_waitcnt lgkmcnt(0)
    v_mfma_f32_32x32x16_bf16 v[32:47], v[128:131], v[136:139], v[32:47]
    v_mfma_f32_32x32x16_bf16 v[48:63], v[128:131], v[140:143], v[48:63]
    v_mfma_f32_32x32x16_bf16 v[48:63], v[132:135], v[136:139], v[48:63]
    ds_read_b128 v[152:155], v20 offset:112
    ds_read2_b32 v[144:145], v18 offset0:48 offset1:49
    ds_read2_b32 v[146:147], v18 offset0:50 offset1:51
    ds_read_b128 v[156:159], v20 offset:624
    ds_read2_b32 v[148:149], v19 offset0:48 offset1:49
    ds_read2_b32 v[150:151], v19 offset0:50 offset1:51
    s_waitcnt lgkmcnt(0)
    v_mfma_f32_32x32x16_bf16 v[32:47], v[144:147], v[152:155], v[32:47]
    v_mfma_f32_32x32x16_bf16 v[48:63], v[144:147], v[156:159], v[48:63]
    v_mfma_f32_32x32x16_bf16 v[48:63], v[148:151], v[152:155], v[48:63]
    ds_read_b128 v[104:107], v20 offset:96
    ds_read2_b32 v[96:97], v18 offset0:64 offset1:65
    ds_read2_b32 v[98:99], v18 offset0:66 offset1:67
    ds_read_b128 v[108:111], v20 offset:608
    ds_read2_b32 v[100:101], v19 offset0:64 offset1:65
    ds_read2_b32 v[102:103], v19 offset0:66 offset1:67
    s_waitcnt lgkmcnt(0)
    v_mfma_f32_32x32x16_bf16 v[32:47], v[96:99], v[104:107], v[32:47]
    v_mfma_f32_32x32x16_bf16 v[48:63], v[96:99], v[108:111], v[48:63]
    v_mfma_f32_32x32x16_bf16 v[48:63], v[100:103], v[104:107], v[48:63]
    ds_read_b128 v[120:123], v20 offset:80
    ds_read2_b32 v[112:113], v18 offset0:80 offset1:81
    ds_read2_b32 v[114:115], v18 offset0:82 offset1:83
    ds_read_b128 v[124:127], v20 offset:592
    ds_read2_b32 v[116:117], v19 offset0:80 offset1:81
    ds_read2_b32 v[118:119], v19 offset0:82 offset1:83
    s_waitcnt lgkmcnt(0)
    v_mfma_f32_32x32x16_bf16 v[32:47], v[112:115], v[120:123], v[32:47]
    v_mfma_f32_32x32x16_bf16 v[48:63], v[112:115], v[124:127], v[48:63]
    v_mfma_f32_32x32x16_bf16 v[48:63], v[116:119], v[120:123], v[48:63]
    ds_read_b128 v[136:139], v20 offset:64
    ds_read2_b32 v[128:129], v18 offset0:96 offset1:97
    ds_read2_b32 v[130:131], v18 offset0:98 offset1:99
    ds_read_b128 v[140:143], v20 offset:576
    ds_read2_b32 v[132:133], v19 offset0:96 offset1:97
    ds_read2_b32 v[134:135], v19 offset0:98 offset1:99
    s_waitcnt lgkmcnt(0)
    v_mfma_f32_32x32x16_bf16 v[32:47], v[128:131], v[136:139], v[32:47]
    v_mfma_f32_32x32x16_bf16 v[48:63], v[128:131], v[140:143], v[48:63]
    v_mfma_f32_32x32x16_bf16 v[48:63], v[132:135], v[136:139], v[48:63]
    ds_read_b128 v[152:155], v20 offset:48
    ds_read2_b32 v[144:145], v18 offset0:112 offset1:113
    ds_read2_b32 v[146:147], v18 offset0:114 offset1:115
    ds_read_b128 v[156:159], v20 offset:560
    ds_read2_b32 v[148:149], v19 offset0:112 offset1:113
    ds_read2_b32 v[150:151], v19 offset0:114 offset1:115
    s_waitcnt lgkmcnt(0)
    v_mfma_f32_32x32x16_bf16 v[32:47], v[144:147], v[152:155], v[32:47]
    v_mfma_f32_32x32x16_bf16 v[48:63], v[144:147], v[156:159], v[48:63]
    v_mfma_f32_32x32x16_bf16 v[48:63], v[148:151], v[152:155], v[48:63]
    ds_read_b128 v[104:107], v20 offset:32
    ds_read2_b32 v[96:97], v18 offset0:128 offset1:129
    ds_read2_b32 v[98:99], v18 offset0:130 offset1:131
    ds_read_b128 v[108:111], v20 offset:544
    ds_read2_b32 v[100:101], v19 offset0:128 offset1:129
    ds_read2_b32 v[102:103], v19 offset0:130 offset1:131
    v_add_u32 v18, 0x200, v18
    v_add_u32 v19, 0x200, v19
    v_subrev_u32 v20, 0x80, v20
    s_sub_u32 s66, s66, 1
    s_cmp_eq_u32 s66, 2
    s_cbranch_scc1 L_fsf
    s_cmp_lg_u32 s66, 0
    s_cbranch_scc1 L_conv
    s_setprio 3
    ds_add_u32 v4, v7 offset:84
    s_lshl_b32 s7, s5, 7
    s_lshl_b32 s6, s54, 1
    s_add_u32 s14, s5, s6
    s_add_u32 s15, s14, 1
    s_and_b32 s14, s14, 7
    s_and_b32 s15, s15, 7
    s_lshl_b32 s14, s14, 16
    s_lshl_b32 s15, s15, 16
    s_add_u32 s14, s14, s7
    s_add_u32 s15, s15, s7
    s_lshl_b32 s72, s54, 13
    s_add_u32 s72, s72, 16384
    s_branch L_lv_37
L_oh3:
    s_branch L_ohx
L_lw_36:
    s_sleep 8
L_lv_37:
    ds_read_b32 v5, v3 offset:20
    s_waitcnt lgkmcnt(0)
    v_readfirstlane_b32 s6, v5
    s_cmp_lt_u32 s6, 72
    s_cbranch_scc1 L_lw_36
    s_add_u32 m0, s72, 0
    s_add_u32 s6, s14, 0
    buffer_load_dwordx4 v1, s[36:39], s6 offen lds
    s_add_u32 s6, s6, 7168
    buffer_load_dwordx4 v1, s[36:39], s6 offen offset:1024 lds
    s_add_u32 s6, s6, 7168
    buffer_load_dwordx4 v1, s[36:39], s6 offen offset:2048 lds
    s_add_u32 s6, s6, 7168
    buffer_load_dwordx4 v1, s[36:39], s6 offen offset:3072 lds
    s_add_u32 m0, s72, 4096
    s_add_u32 s6, s15, 0
    buffer_load_dwordx4 v1, s[36:39], s6 offen lds
    s_add_u32 s6, s6, 7168
    buffer_load_dwordx4 v1, s[36:39], s6 offen offset:1024 lds
    s_add_u32 s6, s6, 7168
    buffer_load_dwordx4 v1, s[36:39], s6 offen offset:2048 lds
    s_add_u32 s6, s6, 7168
    buffer_load_dwordx4 v1, s[36:39], s6 offen offset:3072 lds
L_lw_38:
    ds_read_b32 v5, v4 offset:84
    s_waitcnt lgkmcnt(0)
    v_readfirstlane_b32 s6, v5
    s_cmp_lt_u32 s6, 4
    s_cbranch_scc1 L_lw_38
    s_cmp_eq_u32 s63, 0
    s_cbranch_scc0 L_red1
    ds_write_b128 v24, v[48:51] offset:0
    ds_write_b128 v24, v[52:55] offset:1024
    ds_write_b128 v24, v[56:59] offset:2048
    ds_write_b128 v24, v[60:63] offset:3072
    ds_add_u32 v4, v7 offset:84
L_lw_39:
    ds_read_b32 v5, v4 offset:84
    s_waitcnt lgkmcnt(0)
    v_readfirstlane_b32 s6, v5
    s_cmp_lt_u32 s6, 6
    s_cbranch_scc1 L_lw_39
    ds_read_b128 v[48:51], v25 offset:0
    ds_read_b128 v[52:55], v25 offset:1024
    ds_read_b128 v[56:59], v25 offset:2048
    ds_read_b128 v[60:63], v25 offset:3072
    s_branch L_red2
L_red1:
    ds_write_b128 v24, v[32:35] offset:0
    ds_write_b128 v24, v[36:39] offset:1024
    ds_write_b128 v24, v[40:43] offset:2048
    ds_write_b128 v24, v[44:47] offset:3072
    ds_add_u32 v4, v7 offset:84
L_lw_40:
    ds_read_b32 v5, v4 offset:84
    s_waitcnt lgkmcnt(0)
    v_readfirstlane_b32 s6, v5
    s_cmp_lt_u32 s6, 6
    s_cbranch_scc1 L_lw_40
    ds_read_b128 v[32:35], v25 offset:0
    ds_read_b128 v[36:39], v25 offset:1024
    ds_read_b128 v[40:43], v25 offset:2048
    ds_read_b128 v[44:47], v25 offset:3072
L_red2:
    s_waitcnt lgkmcnt(2)
    v_pk_add_f32 v[32:33], v[32:33], v[48:49]
    v_pk_add_f32 v[34:35], v[34:35], v[50:51]
    v_pk_add_f32 v[36:37], v[36:37], v[52:53]
    v_pk_add_f32 v[38:39], v[38:39], v[54:55]
    v_cvt_pk_bf16_f32 v96, v32, v33
    v_cvt_pk_bf16_f32 v97, v34, v35
    v_cvt_pk_bf16_f32 v98, v36, v37
    v_cvt_pk_bf16_f32 v99, v38, v39
    s_waitcnt lgkmcnt(0)
    v_pk_add_f32 v[40:41], v[40:41], v[56:57]
    v_pk_add_f32 v[42:43], v[42:43], v[58:59]
    v_pk_add_f32 v[44:45], v[44:45], v[60:61]
    v_pk_add_f32 v[46:47], v[46:47], v[62:63]
    v_cvt_pk_bf16_f32 v100, v40, v41
    v_cvt_pk_bf16_f32 v101, v42, v43
    v_cvt_pk_bf16_f32 v102, v44, v45
    v_cvt_pk_bf16_f32 v103, v46, v47
    s_cmp_gt_u32 s13, 4
    s_cbranch_scc1 L_zs1
    buffer_store_dwordx4 v[96:99], v28, s[48:51], s65 offen offset:0
    buffer_store_dwordx4 v[100:103], v28, s[48:51], s65 offen offset:16
L_zs2:
    s_waitcnt vmcnt(2)
    ds_add_u32 v3, v7 offset:100
    v_lshlrev_b32 v32, 16, v8
    v_and_b32 v33, 0xffff0000, v8
    v_lshlrev_b32 v34, 16, v9
    v_and_b32 v35, 0xffff0000, v9
    v_lshlrev_b32 v36, 16, v10
    v_and_b32 v37, 0xffff0000, v10
    v_lshlrev_b32 v38, 16, v11
    v_and_b32 v39, 0xffff0000, v11
    v_lshlrev_b32 v40, 16, v12
    v_and_b32 v41, 0xffff0000, v12
    v_lshlrev_b32 v42, 16, v13
    v_and_b32 v43, 0xffff0000, v13
    v_lshlrev_b32 v44, 16, v14
    v_and_b32 v45, 0xffff0000, v14
    v_lshlrev_b32 v46, 16, v15
    v_and_b32 v47, 0xffff0000, v15
    v_lshlrev_b32 v15, 2, v0
    s_waitcnt vmcnt(0)
    v_mov_b32 v5, s52
    s_mov_b64 exec, 1
    s_cmp_gt_u32 s13, 4
    s_cbranch_scc1 L_zf1
    buffer_store_dword v5, off, s[48:51], s10
L_zf2:
    s_mov_b64 exec, -1
    s_cmp_lg_u32 s54, 0
    s_cbranch_scc1 L_nosp
    v_lshlrev_b32 v8, 3, v0
    s_mov_b64 exec, 0xff
L_gp_41:
    buffer_load_dwordx2 v[10:11], v8, s[48:51], s57 offen sc1
L_gpw_42:
    s_waitcnt vmcnt(0)
    v_cmp_ne_u32 vcc, s52, v10
    s_cbranch_vccz L_gpd_43
    s_mov_b64 exec, vcc
    s_sleep 2
    s_sub_u32 s53, s53, 1
    s_cbranch_scc0 L_gp_41
    s_mov_b32 s53, 0
L_gpd_43:
    s_mov_b64 exec, -1
    s_mov_b64 exec, 0xff
    v_cmp_ne_u32 vcc, s12, v11
    s_mov_b64 exec, -1
    s_cmp_eq_u64 vcc, 0
    s_cselect_b32 s6, 2, 1
    v_mov_b32 v8, s6
    ds_add_u32 v3, v8 offset:40
    s_cmp_lg_u32 s2, 0
    s_cbranch_scc1 L_nosp
    s_mov_b32 s6, 0x40000
    v_mov_b32 v5, s52
    s_mov_b64 exec, 1
    buffer_store_dword v5, off, s[48:51], s6 sc1
    s_mov_b64 exec, -1
L_nosp:
    s_branch L_lv_45
L_lw_44:
    s_sleep 8
L_lv_45:
    ds_read_b32 v5, v3 offset:28
    s_waitcnt lgkmcnt(0)
    v_readfirstlane_b32 s6, v5
    s_cmp_lt_u32 s6, 72
    s_cbranch_scc1 L_lw_44
    s_add_u32 m0, s72, 32768
    s_add_u32 s6, s14, 32768
    buffer_load_dwordx4 v1, s[36:39], s6 offen lds
    s_add_u32 s6, s6, 7168
    buffer_load_dwordx4 v1, s[36:39], s6 offen offset:1024 lds
    s_add_u32 s6, s6, 7168
    buffer_load_dwordx4 v1, s[36:39], s6 offen offset:2048 lds
    s_add_u32 s6, s6, 7168
    buffer_load_dwordx4 v1, s[36:39], s6 offen offset:3072 lds
    s_add_u32 m0, s72, 36864
    s_add_u32 s6, s15, 32768
    buffer_load_dwordx4 v1, s[36:39], s6 offen lds
    s_add_u32 s6, s6, 7168
    buffer_load_dwordx4 v1, s[36:39], s6 offen offset:1024 lds
    s_add_u32 s6, s6, 7168
    buffer_load_dwordx4 v1, s[36:39], s6 offen offset:2048 lds
    s_add_u32 s6, s6, 7168
    buffer_load_dwordx4 v1, s[36:39], s6 offen offset:3072 lds
    s_waitcnt vmcnt(0)
    ds_add_u32 v3, v7 offset:108
L_gp_46:
    buffer_load_dword v9, v15, s[48:51], s11 offen sc1
L_gpw_47:
    s_waitcnt vmcnt(0)
    v_cmp_ne_u32 vcc, s52, v9
    s_cbranch_vccz L_gpd_48
    s_mov_b64 exec, vcc
    s_sleep 4
    s_sub_u32 s53, s53, 1
    s_cbranch_scc0 L_gp_46
    s_mov_b32 s53, 0
L_gpd_48:
    s_mov_b64 exec, -1
    s_mov_b32 m0, s75
    s_nop 0
    buffer_load_dwordx4 v26, s[48:51], s69 offen sc1 lds
    s_add_u32 m0, s75, 1520
    s_nop 0
    buffer_load_dwordx4 v26, s[48:51], s69 offen offset:16 sc1 lds
    s_waitcnt vmcnt(0)
    ds_read_b64_tr_b16 v[8:9], v30
    ds_read_b64_tr_b16 v[10:11], v30 offset:64
    ds_read_b64_tr_b16 v[12:13], v30 offset:512
    ds_read_b64_tr_b16 v[14:15], v30 offset:576
    s_waitcnt lgkmcnt(0)
    v_lshlrev_b32 v48, 16, v8
    v_and_b32 v49, 0xffff0000, v8
    v_lshlrev_b32 v50, 16, v9
    v_and_b32 v51, 0xffff0000, v9
    v_lshlrev_b32 v52, 16, v10
    v_and_b32 v53, 0xffff0000, v10
    v_lshlrev_b32 v54, 16, v11
    v_and_b32 v55, 0xffff0000, v11
    v_lshlrev_b32 v56, 16, v12
    v_and_b32 v57, 0xffff0000, v12
    v_lshlrev_b32 v58, 16, v13
    v_and_b32 v59, 0xffff0000, v13
    v_lshlrev_b32 v60, 16, v14
    v_and_b32 v61, 0xffff0000, v14
    v_lshlrev_b32 v62, 16, v15
    v_and_b32 v63, 0xffff0000, v15
    v_pk_mul_f32 v[32:33], v[32:33], v[48:49]
    v_pk_mul_f32 v[34:35], v[34:35], v[50:51]
    v_pk_mul_f32 v[36:37], v[36:37], v[52:53]
    v_pk_mul_f32 v[38:39], v[38:39], v[54:55]
    v_pk_mul_f32 v[40:41], v[40:41], v[56:57]
    v_pk_mul_f32 v[42:43], v[42:43], v[58:59]
    v_pk_mul_f32 v[44:45], v[44:45], v[60:61]
    v_pk_mul_f32 v[46:47], v[46:47], v[62:63]
    v_cvt_pk_bf16_f32 v8, v32, v33
    v_cvt_pk_bf16_f32 v9, v34, v35
    v_cvt_pk_bf16_f32 v10, v36, v37
    v_cvt_pk_bf16_f32 v11, v38, v39
    v_cvt_pk_bf16_f32 v12, v40, v41
    v_cvt_pk_bf16_f32 v13, v42, v43
    v_cvt_pk_bf16_f32 v14, v44, v45
    v_cvt_pk_bf16_f32 v15, v46, v47
    buffer_store_dwordx4 v[8:11], v2, s[44:47], s73 offen nt
    buffer_store_dwordx4 v[12:15], v2, s[44:47], s73 offen offset:64 nt
    s_lshr_b32 s7, s2, 3
    s_lshl4_add_u32 s7, s7, s3
    s_cmp_lg_u32 s7, 11
    s_cbranch_scc1 L_wb_49
    buffer_wbl2 sc1
L_wb_49:
    s_waitcnt lgkmcnt(0)
    s_branch L_out
L_fsf:
    s_waitcnt vmcnt(0)
    ds_add_u32 v3, v7 offset:48
    v_lshlrev_b32 v17, 5, v0
    buffer_load_dword v166, v17, s[48:51], s56 offen sc1
    s_cmp_lg_u32 s54, 0
    s_cbranch_scc1 L_nofs
    s_lshl_b32 s57, s4, 7
    s_add_u32 s57, s57, 0x43000
    s_lshl_b32 s6, s5, 3
    s_add_u32 s7, s57, s6
    v_mov_b32 v16, s52
    v_mov_b32 v17, s12
L_lw_50:
    ds_read_b32 v5, v3 offset:48
    s_waitcnt lgkmcnt(0)
    v_readfirstlane_b32 s6, v5
    s_cmp_lt_u32 s6, 4
    s_cbranch_scc1 L_lw_50
    s_mov_b64 exec, 1
    buffer_store_dwordx2 v[16:17], off, s[48:51], s7 sc1
    s_mov_b64 exec, -1
L_nofs:
    s_branch L_conv
L_ks1:
    buffer_store_dwordx4 v[128:131], v26, s[48:51], s64 offen offset:0 sc1
    buffer_store_dwordx4 v[132:135], v26, s[48:51], s64 offen offset:1024 sc1
    s_branch L_ks2
L_kf1:
    buffer_store_dword v5, off, s[48:51], s8 sc1
    s_branch L_kf2
L_zs1:
    buffer_store_dwordx4 v[96:99], v28, s[48:51], s65 offen offset:0 sc1
    buffer_store_dwordx4 v[100:103], v28, s[48:51], s65 offen offset:16 sc1
    s_branch L_zs2
L_zf1:
    buffer_store_dword v5, off, s[48:51], s10 sc1
    s_branch L_zf2
.section .rodata,"a"
.p2align 6
.amdhsa_kernel concat_heads__grouped_kv_mqa__ssm_conv_h3__prompt_kernel
  .amdhsa_next_free_vgpr 168
  .amdhsa_next_free_sgpr 102
  .amdhsa_accum_offset 168
  .amdhsa_group_segment_fixed_size 0
  .amdhsa_kernarg_size 112
  .amdhsa_user_sgpr_count 2
  .amdhsa_user_sgpr_kernarg_segment_ptr 1
  .amdhsa_system_sgpr_workgroup_id_x 1
.end_amdhsa_kernel
```
